```python
import torch

def _softmax(x, axis=-1):
    return torch.softmax(x, dim=axis)
def _gelu(x):
    return torch.nn.functional.gelu(x, approximate="tanh")
def _silu(x):
    return torch.nn.functional.silu(x)
def _sigmoid(x):
    return torch.sigmoid(x)
def _layernorm(x, axis=-1, eps=1e-5):
    m = x.mean(dim=axis, keepdim=True)
    v = x.var(dim=axis, keepdim=True, unbiased=False)
    return (x - m) / torch.sqrt(v + eps)
def _scatter_add(tgt, idx, src, axis=0):
    return tgt.clone().index_add_(axis, idx, src)
def _segment_sum(src, seg, n):
    out = torch.zeros((n,) + src.shape[1:], dtype=src.dtype)
    return out.index_add_(0, seg, src)
def _pad(x, pw):
    flat = tuple(v for pair in reversed(pw) for v in pair)
    return torch.nn.functional.pad(x, flat)

kernel_name = 'sequential_preLN__ssm_conv_s4__mixer_token_mlp__prompt'

def setup_inputs():

    _w = (lambda a: (lambda t: t.to(torch.bfloat16) if t.is_floating_point() else t)(torch.as_tensor(a)))
    def _A_setup():
        B, L, D, N = 1, 2048, 512, 128
        A_re = -(lambda _x: torch.exp(torch.as_tensor(_x)))((lambda *s: torch.randn(*s, dtype=torch.bfloat16) * 6.4)(D, N))
        A_im = torch.pi * (lambda *s: torch.randn(*s, dtype=torch.bfloat16) * 0.05)(D, N)
        B_re = (lambda *s: torch.randn(*s, dtype=torch.bfloat16) * 0.1)(D, N)
        B_im = (lambda *s: torch.randn(*s, dtype=torch.bfloat16) * 0.1)(D, N)
        C_re = (lambda *s: torch.randn(*s, dtype=torch.bfloat16) * 0.1)(D, N)
        C_im = (lambda *s: torch.randn(*s, dtype=torch.bfloat16) * 0.1)(D, N)
        log_dt = (lambda *s: torch.randn(*s, dtype=torch.bfloat16) * 0.05)(D) * 0.5 - 4.0
        Dskip = (lambda *s: torch.randn(*s, dtype=torch.bfloat16) * 0.05)(D)
        return {
            "u": _w((lambda *s: torch.randn(*s, dtype=torch.bfloat16) * 0.05)(B, L, D)),
            "A_re": _w(A_re),
            "A_im": _w(A_im),
            "B_re": _w(B_re),
            "B_im": _w(B_im),
            "C_re": _w(C_re),
            "C_im": _w(C_im),
            "log_dt": _w(log_dt),
            "Dskip": _w(Dskip),
        }
    _A_in = _A_setup()

    def _B_setup():
        B, S, D, F = 1, 2048, 512, 1792
        return {
            "x": _w((lambda *s: torch.randn(*s, dtype=torch.bfloat16) * 0.05)(B, S, D)),
            "w1": _w((lambda *s: torch.randn(*s, dtype=torch.bfloat16) * 0.4)(S, F) * (S ** -0.5)),
            "b1": _w((lambda *s: torch.randn(*s, dtype=torch.bfloat16) * 0.1)(F) * 0.02),
            "w2": _w((lambda *s: torch.randn(*s, dtype=torch.bfloat16) * 0.1)(F, S) * (F ** -0.5)),
            "b2": _w((lambda *s: torch.randn(*s, dtype=torch.bfloat16) * 0.1)(S) * 0.02),
        }
    _B_in = _B_setup()

    return {
        "A_u": _A_in["u"],
        "A_A_re": _A_in["A_re"],
        "A_A_im": _A_in["A_im"],
        "A_B_re": _A_in["B_re"],
        "A_B_im": _A_in["B_im"],
        "A_C_re": _A_in["C_re"],
        "A_C_im": _A_in["C_im"],
        "A_log_dt": _A_in["log_dt"],
        "A_Dskip": _A_in["Dskip"],
        "B_x": _B_in["x"],
        "B_w1": _B_in["w1"],
        "B_b1": _B_in["b1"],
        "B_w2": _B_in["w2"],
        "B_b2": _B_in["b2"],
    }

def reference(A_u, A_A_re, A_A_im, A_B_re, A_B_im, A_C_re, A_C_im, A_log_dt, A_Dskip, B_x, B_w1, B_b1, B_w2, B_b2):
    def _A_ref(u, A_re, A_im, B_re, B_im, C_re, C_im, log_dt, Dskip):
        Bsz, L, D = u.shape
        dt = torch.exp(log_dt)[:, None]
        A = A_re + 1j * A_im
        Bc = B_re + 1j * B_im
        Cc = C_re + 1j * C_im
        logdA = dt * A
        dB = dt * Bc
        l = (lambda x, dt: x.to(dt))(torch.arange(L), A_re.dtype)
        P = torch.exp(logdA[:, :, None] * l[None, None, :])
        K = torch.einsum("dn,dnl,dn->dl", Cc, P, dB).real
        L2 = 2 * L
        Kp = _pad(K, ((0, 0), (0, L)))
        up = (lambda x, *d: x.permute(*d))(u, 0, 2, 1)
        up = _pad(up, ((0, 0), (0, 0), (0, L)))
        Kf = (lambda x, axes=(-2,-1): torch.fft.rfft2(x.float(), dim=axes))(Kp[:, None, :], axes=(-2, -1))
        Uf = (lambda x, axes=(-2,-1): torch.fft.rfft2(x.float(), dim=axes))(up[:, :, None, :], axes=(-2, -1))
        Yf = Uf * Kf[None, :, :, :]
        y = (lambda x, s, axes=(-2,-1): torch.fft.irfft2(x, s=s, dim=axes).to(torch.bfloat16))(Yf, (1, L2), axes=(-2, -1))[:, :, 0, :L]
        y = (lambda x, *d: x.permute(*d))(y, 0, 2, 1) + u * Dskip[None, None, :]
        return y

    def _B_ref(x, w1, b1, w2, b2):
        B, S, D = x.shape
        h = _layernorm(x, axis=-1)
        u = torch.einsum("bsd,sf->bdf", h, w1) + b1
        u = _gelu(u)
        y = torch.einsum("bdf,fs->bds", u, w2) + b2
        return (lambda x, *d: x.permute(*d))(y, 0, 2, 1)

    x = A_u
    h = x + _A_ref(_layernorm(x, axis=-1), A_A_re, A_A_im, A_B_re, A_B_im, A_C_re, A_C_im, A_log_dt, A_Dskip)
    h2 = h + _B_ref(_layernorm(h, axis=-1), B_w1, B_b1, B_w2, B_b2)
    return h2
```

```asm
; @launch kernel=fused_kernel grid=(256,1,1) block=(512,1,1) lds=163840
.amdgcn_target "amdgcn-amd-amdhsa--gfx950"
.text
.globl fused_kernel
.p2align 8
.type fused_kernel,@function
fused_kernel:
    s_load_dwordx16 s[36:51], s[0:1], 0
    s_load_dwordx16 s[52:67], s[0:1], 64
    s_load_dwordx2 s[68:69], s[0:1], 128
    s_cmp_ge_u32 s2, 256
    s_cbranch_scc1 L_end_fused_kernel
    s_getpc_b64 s[70:71]
L_pc_fused:
    v_and_b32 v1, 63, v0
    v_lshrrev_b32 v2, 6, v0
    s_lshr_b32 s3, s2, 3
    s_lshl_b32 s3, s3, 3
    v_add_u32 v3, s3, v0
    v_lshlrev_b32 v3, 7, v3
    v_min_u32 v3, L_code_end-L_pc_fused-4, v3
    v_cmp_gt_u32 vcc, 8, v0
    s_and_saveexec_b64 s[4:5], vcc
    s_cbranch_execz L_nopf_fused
    global_load_dword v255, v3, s[70:71]
L_nopf_fused:
    s_mov_b64 exec, s[4:5]
    v_readfirstlane_b32 s6, v2
    s_and_b32 s4, s2, 7
    s_lshr_b32 s5, s2, 3
    s_lshl_b32 s24, s4, 5
    s_add_u32 s24, s24, s5
    s_lshl_b32 s25, s4, 6
    s_lshl_b32 s3, s5, 1
    s_add_u32 s25, s25, s3
    s_mul_i32 s3, s4, 28
    s_add_u32 s3, s3, s5
    s_and_b32 s70, s3, 7
    s_lshr_b32 s71, s3, 3
    s_cmp_ge_u32 s5, 28
    s_cselect_b32 s73, 7, 0
    s_and_b32 s19, s5, 7
    s_lshl_b32 s72, s4, 2
    s_lshr_b32 s3, s5, 3
    s_add_u32 s72, s72, s3
    s_mov_b32 s16, 0
    s_mov_b32 s17, 0
    s_mov_b32 s21, 0xfffffffe
    s_mov_b32 s23, 0
    v_mov_b32 v104, 0
    v_mov_b32 v105, 0
    v_mov_b32 v106, 0
    v_mov_b32 v107, 0
    v_mov_b32 v128, -1
    v_mov_b32 v129, -1
    v_mov_b32 v130, -1
    v_mov_b32 v131, -1
    s_waitcnt lgkmcnt(0)
    s_mov_b32 s8, s68
    s_mov_b32 s9, s69
    s_mov_b32 s10, 25165824
    s_mov_b32 s11, 0x20000
    s_mov_b32 s12, s36
    s_mov_b32 s13, s37
    s_mov_b32 s14, 2097152
    s_mov_b32 s15, 0x20000
    s_add_u32 s34, s68, 16777216
    s_addc_u32 s35, s69, 0
    s_load_dword s20, s[34:35], 0
    s_lshl_b32 s26, s24, 3
    s_add_u32 s26, s26, s6
    s_lshl_b32 s26, s26, 10
    v_lshlrev_b32 v3, 4, v1
    buffer_load_dwordx4 v[120:123], v3, s[12:15], s26 offen
    s_barrier
    s_lshr_b32 s27, s6, 2
    s_bfe_u32 s28, s6, 0x10001
    s_and_b32 s29, s6, 1
    s_add_u32 s30, s25, s28
    s_lshl_b32 s30, s30, 8
    s_lshl_b32 s31, s29, 7
    s_add_u32 s30, s30, s31
    v_lshlrev_b32 v2, 1, v1
    v_add_u32 v2, s30, v2
    global_load_ushort v50, v2, s[38:39]
    global_load_ushort v51, v2, s[40:41]
    global_load_ushort v52, v2, s[42:43]
    global_load_ushort v53, v2, s[44:45]
    global_load_ushort v54, v2, s[46:47]
    global_load_ushort v55, v2, s[48:49]
    v_lshlrev_b32 v2, 4, v1
    global_load_dwordx4 v[64:67], v2, s[52:53]
    s_lshl_b32 s31, s25, 1
    s_load_dword s32, s[50:51], s31
    v_and_b32 v3, 255, v0
    v_lshlrev_b32 v3, 3, v3
    v_sub_u32 v3, 2047, v3
    v_cvt_f32_u32 v5, v3
    v_lshrrev_b32 v4, 8, v0
    v_mul_u32_u24 v4, 1344, v4
    v_add_u32 v4, 64512, v4
    v_subrev_f32 v6, 0x00000000, v5
    v_subrev_f32 v7, 0x3f800000, v5
    v_cvt_pk_bf16_f32 v6, v6, v7
    v_and_b32 v7, 0xffff, v6
    v_lshl_add_u32 v108, v7, 1, v4
    v_lshrrev_b32 v7, 16, v6
    v_lshl_add_u32 v109, v7, 1, v4
    v_subrev_f32 v6, 0x40000000, v5
    v_subrev_f32 v7, 0x40400000, v5
    v_cvt_pk_bf16_f32 v6, v6, v7
    v_and_b32 v7, 0xffff, v6
    v_lshl_add_u32 v110, v7, 1, v4
    v_lshrrev_b32 v7, 16, v6
    v_lshl_add_u32 v111, v7, 1, v4
    v_subrev_f32 v6, 0x40800000, v5
    v_subrev_f32 v7, 0x40a00000, v5
    v_cvt_pk_bf16_f32 v6, v6, v7
    v_and_b32 v7, 0xffff, v6
    v_lshl_add_u32 v112, v7, 1, v4
    v_lshrrev_b32 v7, 16, v6
    v_lshl_add_u32 v113, v7, 1, v4
    v_subrev_f32 v6, 0x40c00000, v5
    v_subrev_f32 v7, 0x40e00000, v5
    v_cvt_pk_bf16_f32 v6, v6, v7
    v_and_b32 v7, 0xffff, v6
    v_lshl_add_u32 v114, v7, 1, v4
    v_lshrrev_b32 v7, 16, v6
    v_lshl_add_u32 v115, v7, 1, v4
    v_subrev_f32 v6, 0x41000000, v5
    v_subrev_f32 v7, 0x41100000, v5
    v_cvt_pk_bf16_f32 v6, v6, v7
    v_and_b32 v7, 0xffff, v6
    v_lshl_add_u32 v116, v7, 1, v4
    v_lshrrev_b32 v7, 16, v6
    v_lshl_add_u32 v117, v7, 1, v4
    v_subrev_f32 v6, 0x41200000, v5
    v_cvt_pk_bf16_f32 v6, v6, v6
    v_and_b32 v7, 0xffff, v6
    v_lshl_add_u32 v118, v7, 1, v4
    s_and_b32 s3, s6, 3
    s_cmp_eq_u32 s3, 3
    s_cbranch_scc0 Lfix_fused_kernel_1
    v_add_u32 v4, 34048, v4
    v_subrev_u32 v5, 0, v3
    v_lshl_add_u32 v6, v5, 1, v4
    v_cmp_gt_i32 vcc, 0x100, v5
    s_nop 1
    v_cndmask_b32 v108, v108, v6, vcc
    v_subrev_u32 v5, 1, v3
    v_lshl_add_u32 v6, v5, 1, v4
    v_cmp_gt_i32 vcc, 0x100, v5
    s_nop 1
    v_cndmask_b32 v109, v109, v6, vcc
    v_subrev_u32 v5, 2, v3
    v_lshl_add_u32 v6, v5, 1, v4
    v_cmp_gt_i32 vcc, 0x100, v5
    s_nop 1
    v_cndmask_b32 v110, v110, v6, vcc
    v_subrev_u32 v5, 3, v3
    v_lshl_add_u32 v6, v5, 1, v4
    v_cmp_gt_i32 vcc, 0x100, v5
    s_nop 1
    v_cndmask_b32 v111, v111, v6, vcc
    v_subrev_u32 v5, 4, v3
    v_lshl_add_u32 v6, v5, 1, v4
    v_cmp_gt_i32 vcc, 0x100, v5
    s_nop 1
    v_cndmask_b32 v112, v112, v6, vcc
    v_subrev_u32 v5, 5, v3
    v_lshl_add_u32 v6, v5, 1, v4
    v_cmp_gt_i32 vcc, 0x100, v5
    s_nop 1
    v_cndmask_b32 v113, v113, v6, vcc
    v_subrev_u32 v5, 6, v3
    v_lshl_add_u32 v6, v5, 1, v4
    v_cmp_gt_i32 vcc, 0x100, v5
    s_nop 1
    v_cndmask_b32 v114, v114, v6, vcc
    v_subrev_u32 v5, 7, v3
    v_lshl_add_u32 v6, v5, 1, v4
    v_cmp_gt_i32 vcc, 0x100, v5
    s_nop 1
    v_cndmask_b32 v115, v115, v6, vcc
    v_subrev_u32 v5, 8, v3
    v_lshl_add_u32 v6, v5, 1, v4
    v_cmp_gt_i32 vcc, 0x100, v5
    s_nop 1
    v_cndmask_b32 v116, v116, v6, vcc
    v_add_u32 v6, 1282, v4
    v_cmp_gt_i32 vcc, 0, v5
    s_nop 1
    v_cndmask_b32 v116, v116, v6, vcc
    v_subrev_u32 v5, 9, v3
    v_lshl_add_u32 v6, v5, 1, v4
    v_cmp_gt_i32 vcc, 0x100, v5
    s_nop 1
    v_cndmask_b32 v117, v117, v6, vcc
    v_add_u32 v6, 1282, v4
    v_cmp_gt_i32 vcc, 0, v5
    s_nop 1
    v_cndmask_b32 v117, v117, v6, vcc
    v_subrev_u32 v5, 10, v3
    v_lshl_add_u32 v6, v5, 1, v4
    v_cmp_gt_i32 vcc, 0x100, v5
    s_nop 1
    v_cndmask_b32 v118, v118, v6, vcc
    v_add_u32 v6, 1282, v4
    v_cmp_gt_i32 vcc, 0, v5
    s_nop 1
    v_cndmask_b32 v118, v118, v6, vcc
Lfix_fused_kernel_1:
    s_lshr_b32 s33, s6, 2
    s_and_b32 s18, s6, 3
    v_and_b32 v3, 15, v1
    v_lshrrev_b32 v4, 4, v1
    v_and_b32 v5, 7, v3
    s_lshl_b32 s7, s18, 3
    s_add_u32 s7, s7, 8
    v_add_u32 v5, s7, v5
    v_mov_b32 v6, 40
    v_cmp_gt_u32 vcc, 8, v3
    s_nop 1
    v_cndmask_b32 v6, v5, v6, vcc
    s_cmp_eq_u32 s18, 3
    s_cselect_b64 s[34:35], -1, 0
    v_cndmask_b32 v5, v5, v6, s[34:35]
    s_cmp_eq_u32 s18, 0
    s_cselect_b64 s[34:35], -1, 0
    v_cndmask_b32 v5, v5, v3, s[34:35]
    v_lshlrev_b32 v6, s18, v3
    v_lshrrev_b32 v7, 1, v6
    v_add_u32 v7, 8, v7
    v_cmp_lt_u32 vcc, 15, v6
    s_nop 1
    v_cndmask_b32 v8, v6, v7, vcc
    v_lshrrev_b32 v7, 2, v6
    v_add_u32 v7, 16, v7
    v_cmp_lt_u32 vcc, 31, v6
    s_nop 1
    v_cndmask_b32 v8, v8, v7, vcc
    v_lshrrev_b32 v7, 3, v6
    v_add_u32 v7, 24, v7
    v_cmp_lt_u32 vcc, 63, v6
    s_nop 1
    v_cndmask_b32 v8, v8, v7, vcc
    s_mul_i32 s7, s33, 49152
    s_add_u32 s7, s7, 256
    v_mul_u32_u24 v4, 6144, v4
    v_add_u32 v4, s7, v4
    v_mul_u32_u24 v5, 144, v5
    v_add_u32 v5, v5, v4
    v_mul_u32_u24 v8, 144, v8
    v_add_u32 v8, v8, v4
    v_lshrrev_b32 v4, 4, v1
    v_lshlrev_b32 v4, 6, v4
    v_add_u32 v4, v4, v3
    s_lshl_b32 s7, s18, 7
    v_add_u32 v4, s7, v4
    v_lshlrev_b32 v4, 1, v4
    s_mul_i32 s7, s33, 1344
    s_add_u32 s7, s7, 98560
    v_add_u32 v4, s7, v4
    v_mov_b32 v132, v5
    v_mov_b32 v133, v8
    v_mov_b32 v134, v4
    v_cmp_gt_u32 vcc, 4, v0
    s_and_saveexec_b64 s[34:35], vcc
    v_lshlrev_b32 v4, 2, v0
    v_add_u32 v4, 163776, v4
    ds_write_b32 v4, v104
    s_mov_b64 exec, s[34:35]
    v_lshrrev_b32 v4, 7, v0
    v_mul_u32_u24 v4, 6272, v4
    v_bfe_u32 v5, v0, 5, 2
    v_mul_u32_u24 v5, 1552, v5
    v_and_b32 v6, 31, v0
    v_lshlrev_b32 v6, 4, v6
    v_add3_u32 v4, v4, v5, v6
    v_add_u32 v4, 101632, v4
    v_cmp_gt_u32 vcc, 256, v0
    s_and_saveexec_b64 s[34:35], vcc
    ds_write_b128 v4, v[104:107]
    s_mov_b64 exec, s[34:35]
    s_and_b32 s3, s6, 3
    s_mul_i32 s3, s3, 2112
    s_lshr_b32 s7, s6, 2
    s_lshl_b32 s7, s7, 2
    s_add_u32 s3, s3, s7
    s_add_u32 s3, s3, 114176
    v_lshlrev_b32 v100, 3, v1
    v_add_u32 v100, s3, v100
    v_bfe_u32 v101, v1, 2, 2
    v_mul_u32_u24 v101, 2112, v101
    v_lshrrev_b32 v2, 4, v1
    v_lshl_add_u32 v101, v2, 3, v101
    v_and_b32 v2, 3, v1
    v_mul_u32_u24 v2, 528, v2
    v_add_u32 v101, v101, v2
    s_lshl_b32 s3, s6, 6
    s_add_u32 s3, s3, 114176
    v_add_u32 v101, s3, v101
    s_mul_i32 s30, s28, 49152
    s_mul_i32 s31, s27, 24576
    s_add_u32 s30, s30, s31
    s_mul_i32 s31, s29, 12288
    s_add_u32 s30, s30, s31
    s_add_u32 s30, s30, 256
    v_lshrrev_b32 v4, 5, v1
    v_mul_u32_u24 v4, 6144, v4
    v_and_b32 v5, 31, v1
    v_lshlrev_b32 v5, 2, v5
    v_add3_u32 v102, v4, v5, s30
    s_sub_u32 s3, s6, 0
    s_cmp_le_u32 s3, 0
    s_cselect_b64 exec, -1, 1
    s_cselect_b32 s3, s3, 0
    s_add_u32 s3, s3, 0
    s_lshl_b32 s3, s3, 6
    s_lshr_b32 s3, s3, 2
    s_lshl_b32 s7, s5, 6
    s_add_u32 s3, s3, s7
    v_lshrrev_b32 v119, 2, v1
    v_add_u32 v119, s3, v119
    v_mul_u32_u24 v119, 3584, v119
    v_and_b32 v103, 3, v1
    v_lshl_add_u32 v119, v103, 7, v119
    s_mul_i32 s3, s4, 7
    s_lshr_b32 s3, s3, 1
    s_lshl_b32 s3, s3, 7
    v_add_u32 v119, s3, v119
    global_load_dword v254, v119, s[56:57]
    s_mov_b64 exec, -1
    s_waitcnt vmcnt(8)
    v_lshlrev_b32 v8, 16, v120
    v_and_b32 v9, 0xffff0000, v120
    v_lshlrev_b32 v10, 16, v121
    v_and_b32 v11, 0xffff0000, v121
    v_lshlrev_b32 v12, 16, v122
    v_and_b32 v13, 0xffff0000, v122
    v_lshlrev_b32 v14, 16, v123
    v_and_b32 v15, 0xffff0000, v123
    v_readfirstlane_b32 s35, v8
    s_nop 1
    v_subrev_f32 v28, s35, v8
    v_subrev_f32 v29, s35, v9
    v_subrev_f32 v30, s35, v10
    v_subrev_f32 v31, s35, v11
    v_subrev_f32 v32, s35, v12
    v_subrev_f32 v33, s35, v13
    v_subrev_f32 v34, s35, v14
    v_subrev_f32 v35, s35, v15
    v_add_f32 v24, v28, v29
    v_mul_f32 v25, v28, v28
    v_add_f32 v26, v30, v31
    v_mul_f32 v27, v29, v29
    v_add_f32 v24, v24, v32
    v_fmac_f32 v25, v30, v30
    v_add_f32 v26, v26, v33
    v_fmac_f32 v27, v31, v31
    v_add_f32 v24, v24, v34
    v_fmac_f32 v25, v32, v32
    v_add_f32 v26, v26, v35
    v_fmac_f32 v27, v33, v33
    v_fmac_f32 v25, v34, v34
    v_fmac_f32 v27, v35, v35
    v_add_f32 v24, v24, v26
    v_add_f32 v25, v25, v27
    s_nop 0
    v_add_f32_dpp v24, v24, v24 row_ror:8 row_mask:0xf bank_mask:0xf
    v_add_f32_dpp v25, v25, v25 row_ror:8 row_mask:0xf bank_mask:0xf
    s_nop 0
    v_add_f32_dpp v24, v24, v24 row_ror:4 row_mask:0xf bank_mask:0xf
    v_add_f32_dpp v25, v25, v25 row_ror:4 row_mask:0xf bank_mask:0xf
    s_nop 0
    v_add_f32_dpp v24, v24, v24 row_ror:2 row_mask:0xf bank_mask:0xf
    v_add_f32_dpp v25, v25, v25 row_ror:2 row_mask:0xf bank_mask:0xf
    s_nop 0
    v_add_f32_dpp v24, v24, v24 row_ror:1 row_mask:0xf bank_mask:0xf
    v_add_f32_dpp v25, v25, v25 row_ror:1 row_mask:0xf bank_mask:0xf
    s_nop 0
    v_add_f32_dpp v24, v24, v24 row_bcast:15 row_mask:0xa bank_mask:0xf
    v_add_f32_dpp v25, v25, v25 row_bcast:15 row_mask:0xa bank_mask:0xf
    s_nop 0
    v_add_f32_dpp v24, v24, v24 row_bcast:31 row_mask:0xc bank_mask:0xf
    v_add_f32_dpp v25, v25, v25 row_bcast:31 row_mask:0xc bank_mask:0xf
    v_readlane_b32 s33, v24, 63
    v_readlane_b32 s34, v25, 63
    s_nop 0
    v_mov_b32 v24, s33
    v_mov_b32 v25, s34
    v_mul_f32 v24, 0x3b000000, v24
    v_mul_f32 v25, 0x3b000000, v25
    v_fma_f32 v25, -v24, v24, v25
    v_add_f32 v24, s35, v24
    v_max_f32 v25, 0, v25
    v_cvt_pk_bf16_f32 v24, v24, v25
    v_and_b32 v25, 0xffff0000, v24
    v_lshlrev_b32 v24, 16, v24
    v_add_f32 v25, 0x3727c5ac, v25
    v_sub_f32 v28, v8, v24
    v_sub_f32 v29, v9, v24
    v_sub_f32 v30, v10, v24
    v_sub_f32 v31, v11, v24
    v_cvt_pk_bf16_f32 v25, v25, v25
    v_and_b32 v25, 0xffff0000, v25
    v_sub_f32 v32, v12, v24
    v_sub_f32 v33, v13, v24
    v_sub_f32 v34, v14, v24
    v_sub_f32 v35, v15, v24
    v_sqrt_f32 v25, v25
    v_cvt_pk_bf16_f32 v124, v28, v29
    v_cvt_pk_bf16_f32 v125, v30, v31
    v_cvt_pk_bf16_f32 v126, v32, v33
    v_cvt_pk_bf16_f32 v127, v34, v35
    v_cvt_pk_bf16_f32 v25, v25, v25
    v_and_b32 v25, 0xffff0000, v25
    v_lshlrev_b32 v28, 16, v124
    v_and_b32 v29, 0xffff0000, v124
    v_lshlrev_b32 v30, 16, v125
    v_and_b32 v31, 0xffff0000, v125
    v_rcp_f32 v25, v25
    v_lshlrev_b32 v32, 16, v126
    v_and_b32 v33, 0xffff0000, v126
    v_lshlrev_b32 v34, 16, v127
    v_and_b32 v35, 0xffff0000, v127
    v_mul_f32 v28, v28, v25
    v_mul_f32 v29, v29, v25
    v_mul_f32 v30, v30, v25
    v_mul_f32 v31, v31, v25
    v_mul_f32 v32, v32, v25
    v_mul_f32 v33, v33, v25
    v_mul_f32 v34, v34, v25
    v_mul_f32 v35, v35, v25
    v_cvt_pk_bf16_f32 v124, v28, v29
    v_cvt_pk_bf16_f32 v125, v30, v31
    v_cvt_pk_bf16_f32 v126, v32, v33
    v_cvt_pk_bf16_f32 v127, v34, v35
    ds_write_b32 v100, v124 offset:0
    ds_write_b32 v100, v125 offset:528
    ds_write_b32 v100, v126 offset:1056
    ds_write_b32 v100, v127 offset:1584
    s_waitcnt lgkmcnt(0)
    s_add_u32 s20, s20, 1
    s_xor_b32 s22, s20, 0x5a5a5a5a
    s_barrier
    ds_read_b64_tr_b16 v[44:45], v101
    ds_read_b64_tr_b16 v[56:57], v101 offset:32
    v_mov_b32 v46, s20
    v_mov_b32 v47, s22
    v_mov_b32 v58, s20
    v_mov_b32 v59, s22
    s_lshl_b32 s30, s24, 14
    s_add_u32 s30, s30, 0
    v_lshlrev_b32 v3, 4, v1
    s_lshl_b32 s31, s6, 11
    s_add_u32 s30, s30, s31
    s_waitcnt lgkmcnt(0)
    buffer_store_dwordx4 v[44:47], v3, s[8:11], s30 offen sc1
    buffer_store_dwordx4 v[56:59], v3, s[8:11], s30 offen offset:1024 sc1
    s_sub_u32 s3, s6, 1
    s_cmp_le_u32 s3, 2
    s_cselect_b64 exec, -1, 1
    s_cselect_b32 s3, s3, 0
    s_add_u32 s3, s3, 1
    s_lshl_b32 s3, s3, 6
    s_lshr_b32 s3, s3, 2
    s_lshl_b32 s7, s5, 6
    s_add_u32 s3, s3, s7
    v_lshrrev_b32 v119, 2, v1
    v_add_u32 v119, s3, v119
    v_mul_u32_u24 v119, 3584, v119
    v_and_b32 v103, 3, v1
    v_lshl_add_u32 v119, v103, 7, v119
    s_mul_i32 s3, s4, 7
    s_lshr_b32 s3, s3, 1
    s_lshl_b32 s3, s3, 7
    v_add_u32 v119, s3, v119
    global_load_dword v254, v119, s[56:57]
    s_mov_b64 exec, -1
    s_waitcnt vmcnt(4)
    v_lshlrev_b32 v24, 16, v124
    v_and_b32 v25, 0xffff0000, v124
    v_lshlrev_b32 v26, 16, v125
    v_and_b32 v27, 0xffff0000, v125
    v_lshlrev_b32 v28, 16, v126
    v_and_b32 v29, 0xffff0000, v126
    v_lshlrev_b32 v30, 16, v127
    v_and_b32 v31, 0xffff0000, v127
    v_lshlrev_b32 v8, 16, v64
    v_and_b32 v9, 0xffff0000, v64
    v_lshlrev_b32 v10, 16, v65
    v_and_b32 v11, 0xffff0000, v65
    v_lshlrev_b32 v12, 16, v66
    v_and_b32 v13, 0xffff0000, v66
    v_lshlrev_b32 v14, 16, v67
    v_and_b32 v15, 0xffff0000, v67
    v_mul_f32 v24, v24, v8
    v_mul_f32 v25, v25, v9
    v_mul_f32 v26, v26, v10
    v_mul_f32 v27, v27, v11
    v_mul_f32 v28, v28, v12
    v_mul_f32 v29, v29, v13
    v_mul_f32 v30, v30, v14
    v_mul_f32 v31, v31, v15
    v_cvt_pk_bf16_f32 v124, v24, v25
    v_cvt_pk_bf16_f32 v125, v26, v27
    v_cvt_pk_bf16_f32 v126, v28, v29
    v_cvt_pk_bf16_f32 v127, v30, v31
    s_lshl_b32 s33, s32, 16
    s_and_b32 s34, s32, 0xffff0000
    s_cmp_eq_u32 s28, 0
    s_cselect_b32 s33, s33, s34
    v_mov_b32 v12, s33
    v_mul_f32 v13, 0x3fb8aa3b, v12
    s_mov_b32 s34, 0x3fb8aa3b
    v_fma_f32 v14, v12, s34, -v13
    s_mov_b32 s34, 0x32a57060
    v_fma_f32 v14, v12, s34, v14
    v_exp_f32 v13, v13
    v_mul_f32 v14, 0x3f317218, v14
    v_fma_f32 v12, v13, v14, v13
    v_cvt_pk_bf16_f32 v12, v12, v12
    v_and_b32 v12, 0xffff0000, v12
    v_lshlrev_b32 v4, 16, v50
    v_lshlrev_b32 v5, 16, v51
    v_lshlrev_b32 v6, 16, v52
    v_lshlrev_b32 v7, 16, v53
    v_lshlrev_b32 v8, 16, v54
    v_lshlrev_b32 v9, 16, v55
    v_mul_f32 v4, v12, v4
    v_mul_f32 v5, v12, v5
    v_mul_f32 v4, 0x3fb8aa3b, v4
    v_mul_f32 v5, 0x3e22f983, v5
    s_cmp_eq_u32 s27, 1
    s_cbranch_scc1 Lrole_fused_kernel_2
    v_mul_f32 v6, v12, v6
    v_mul_f32 v7, v12, v7
    v_mul_f32 v14, v9, v7
    v_mul_f32 v17, v8, v7
    v_fma_f32 v16, v8, v6, -v14
    v_fmac_f32 v17, v9, v6
    v_mul_f32 v14, 0x41800000, v4
    v_mul_f32 v15, 0x41800000, v5
    v_exp_f32 v14, v14
    v_fract_f32 v15, v15
    v_cos_f32 v18, v15
    v_sin_f32 v19, v15
    v_mul_f32 v18, v18, v14
    v_mul_f32 v19, v19, v14
    v_mul_f32 v32, 0x43800000, v4
    v_mul_f32 v33, 0x43800000, v5
    v_exp_f32 v32, v32
    v_fract_f32 v33, v33
    v_cos_f32 v26, v33
    v_sin_f32 v27, v33
    v_mul_f32 v26, v26, v32
    v_mul_f32 v27, v27, v32
    v_mul_f32 v14, v19, v19
    v_mul_f32 v15, v27, v27
    v_mul_f32 v21, v18, v19
    v_mul_f32 v29, v26, v27
    v_fma_f32 v20, v18, v18, -v14
    v_fma_f32 v28, v26, v26, -v15
    v_add_f32 v21, v21, v21
    v_add_f32 v29, v29, v29
    v_mul_f32 v14, v21, v21
    v_mul_f32 v15, v29, v29
    v_mul_f32 v23, v20, v21
    v_mul_f32 v31, v28, v29
    v_fma_f32 v22, v20, v20, -v14
    v_fma_f32 v30, v28, v28, -v15
    v_add_f32 v23, v23, v23
    v_add_f32 v31, v31, v31
    v_mul_f32 v14, v23, v23
    v_mul_f32 v25, v22, v23
    v_fma_f32 v24, v22, v22, -v14
    v_add_f32 v25, v25, v25
    v_mul_f32 v61, v17, v25
    v_mul_f32 v62, v17, v27
    v_mul_f32 v63, v17, v29
    v_mul_f32 v64, v17, v31
    v_mul_f32 v45, v16, v25
    v_mul_f32 v49, v16, v27
    v_mul_f32 v53, v16, v29
    v_mul_f32 v57, v16, v31
    v_fma_f32 v44, v16, v24, -v61
    v_fma_f32 v48, v16, v26, -v62
    v_fma_f32 v52, v16, v28, -v63
    v_fma_f32 v56, v16, v30, -v64
    v_fmac_f32 v45, v17, v24
    v_fmac_f32 v49, v17, v26
    v_fmac_f32 v53, v17, v28
    v_fmac_f32 v57, v17, v30
    v_mov_b32 v40, v16
    v_mov_b32 v41, v17
    v_cvt_pk_bf16_f32 v66, v40, v41
    ds_write_b32 v102, v66 offset:0
    v_cvt_pk_bf16_f32 v67, v44, v45
    ds_write_b32 v102, v67 offset:1152
    v_cvt_pk_bf16_f32 v68, v48, v49
    ds_write_b32 v102, v68 offset:2304
    v_cvt_pk_bf16_f32 v69, v52, v53
    ds_write_b32 v102, v69 offset:3456
    v_cvt_pk_bf16_f32 v70, v56, v57
    ds_write_b32 v102, v70 offset:4608
    v_mul_f32 v60, v41, v19
    v_mul_f32 v61, v45, v19
    v_mul_f32 v62, v49, v21
    v_mul_f32 v63, v53, v23
    v_mul_f32 v64, v57, v25
    v_mul_f32 v43, v40, v19
    v_mul_f32 v47, v44, v19
    v_mul_f32 v51, v48, v21
    v_mul_f32 v55, v52, v23
    v_mul_f32 v59, v56, v25
    v_fma_f32 v42, v40, v18, -v60
    v_fma_f32 v46, v44, v18, -v61
    v_fma_f32 v50, v48, v20, -v62
    v_fma_f32 v54, v52, v22, -v63
    v_fma_f32 v58, v56, v24, -v64
    v_fmac_f32 v43, v41, v18
    v_fmac_f32 v47, v45, v18
    v_fmac_f32 v51, v49, v20
    v_fmac_f32 v55, v53, v22
    v_fmac_f32 v59, v57, v24
    v_cvt_pk_bf16_f32 v66, v42, v43
    ds_write_b32 v102, v66 offset:144
    v_cvt_pk_bf16_f32 v67, v46, v47
    ds_write_b32 v102, v67 offset:1296
    v_cvt_pk_bf16_f32 v68, v50, v51
    ds_write_b32 v102, v68 offset:2448
    v_cvt_pk_bf16_f32 v69, v54, v55
    ds_write_b32 v102, v69 offset:3600
    v_cvt_pk_bf16_f32 v70, v58, v59
    ds_write_b32 v102, v70 offset:4752
    v_mul_f32 v60, v43, v19
    v_mul_f32 v61, v47, v19
    v_mul_f32 v62, v51, v21
    v_mul_f32 v63, v55, v23
    v_mul_f32 v64, v59, v25
    v_mul_f32 v41, v42, v19
    v_mul_f32 v45, v46, v19
    v_mul_f32 v49, v50, v21
    v_mul_f32 v53, v54, v23
    v_mul_f32 v57, v58, v25
    v_fma_f32 v40, v42, v18, -v60
    v_fma_f32 v44, v46, v18, -v61
    v_fma_f32 v48, v50, v20, -v62
    v_fma_f32 v52, v54, v22, -v63
    v_fma_f32 v56, v58, v24, -v64
    v_fmac_f32 v41, v43, v18
    v_fmac_f32 v45, v47, v18
    v_fmac_f32 v49, v51, v20
    v_fmac_f32 v53, v55, v22
    v_fmac_f32 v57, v59, v24
    v_cvt_pk_bf16_f32 v66, v40, v41
    ds_write_b32 v102, v66 offset:288
    v_cvt_pk_bf16_f32 v67, v44, v45
    ds_write_b32 v102, v67 offset:1440
    v_cvt_pk_bf16_f32 v68, v48, v49
    ds_write_b32 v102, v68 offset:2592
    v_cvt_pk_bf16_f32 v69, v52, v53
    ds_write_b32 v102, v69 offset:3744
    v_cvt_pk_bf16_f32 v70, v56, v57
    ds_write_b32 v102, v70 offset:4896
    v_mul_f32 v60, v41, v19
    v_mul_f32 v61, v45, v19
    v_mul_f32 v62, v49, v21
    v_mul_f32 v63, v53, v23
    v_mul_f32 v64, v57, v25
    v_mul_f32 v43, v40, v19
    v_mul_f32 v47, v44, v19
    v_mul_f32 v51, v48, v21
    v_mul_f32 v55, v52, v23
    v_mul_f32 v59, v56, v25
    v_fma_f32 v42, v40, v18, -v60
    v_fma_f32 v46, v44, v18, -v61
    v_fma_f32 v50, v48, v20, -v62
    v_fma_f32 v54, v52, v22, -v63
    v_fma_f32 v58, v56, v24, -v64
    v_fmac_f32 v43, v41, v18
    v_fmac_f32 v47, v45, v18
    v_fmac_f32 v51, v49, v20
    v_fmac_f32 v55, v53, v22
    v_fmac_f32 v59, v57, v24
    v_cvt_pk_bf16_f32 v66, v42, v43
    ds_write_b32 v102, v66 offset:432
    v_cvt_pk_bf16_f32 v67, v46, v47
    ds_write_b32 v102, v67 offset:1584
    v_cvt_pk_bf16_f32 v68, v50, v51
    ds_write_b32 v102, v68 offset:2736
    v_cvt_pk_bf16_f32 v69, v54, v55
    ds_write_b32 v102, v69 offset:3888
    v_cvt_pk_bf16_f32 v70, v58, v59
    ds_write_b32 v102, v70 offset:5040
    v_mul_f32 v60, v43, v19
    v_mul_f32 v61, v47, v19
    v_mul_f32 v62, v51, v21
    v_mul_f32 v63, v55, v23
    v_mul_f32 v64, v59, v25
    v_mul_f32 v41, v42, v19
    v_mul_f32 v45, v46, v19
    v_mul_f32 v49, v50, v21
    v_mul_f32 v53, v54, v23
    v_mul_f32 v57, v58, v25
    v_fma_f32 v40, v42, v18, -v60
    v_fma_f32 v44, v46, v18, -v61
    v_fma_f32 v48, v50, v20, -v62
    v_fma_f32 v52, v54, v22, -v63
    v_fma_f32 v56, v58, v24, -v64
    v_fmac_f32 v41, v43, v18
    v_fmac_f32 v45, v47, v18
    v_fmac_f32 v49, v51, v20
    v_fmac_f32 v53, v55, v22
    v_fmac_f32 v57, v59, v24
    v_cvt_pk_bf16_f32 v66, v40, v41
    ds_write_b32 v102, v66 offset:576
    v_cvt_pk_bf16_f32 v67, v44, v45
    ds_write_b32 v102, v67 offset:1728
    v_cvt_pk_bf16_f32 v68, v48, v49
    ds_write_b32 v102, v68 offset:2880
    v_cvt_pk_bf16_f32 v69, v52, v53
    ds_write_b32 v102, v69 offset:4032
    v_cvt_pk_bf16_f32 v70, v56, v57
    ds_write_b32 v102, v70 offset:5184
    v_mul_f32 v60, v41, v19
    v_mul_f32 v61, v45, v19
    v_mul_f32 v62, v49, v21
    v_mul_f32 v63, v53, v23
    v_mul_f32 v64, v57, v25
    v_mul_f32 v43, v40, v19
    v_mul_f32 v47, v44, v19
    v_mul_f32 v51, v48, v21
    v_mul_f32 v55, v52, v23
    v_mul_f32 v59, v56, v25
    v_fma_f32 v42, v40, v18, -v60
    v_fma_f32 v46, v44, v18, -v61
    v_fma_f32 v50, v48, v20, -v62
    v_fma_f32 v54, v52, v22, -v63
    v_fma_f32 v58, v56, v24, -v64
    v_fmac_f32 v43, v41, v18
    v_fmac_f32 v47, v45, v18
    v_fmac_f32 v51, v49, v20
    v_fmac_f32 v55, v53, v22
    v_fmac_f32 v59, v57, v24
    v_cvt_pk_bf16_f32 v66, v42, v43
    ds_write_b32 v102, v66 offset:720
    v_cvt_pk_bf16_f32 v67, v46, v47
    ds_write_b32 v102, v67 offset:1872
    v_cvt_pk_bf16_f32 v68, v50, v51
    ds_write_b32 v102, v68 offset:3024
    v_cvt_pk_bf16_f32 v69, v54, v55
    ds_write_b32 v102, v69 offset:4176
    v_cvt_pk_bf16_f32 v70, v58, v59
    ds_write_b32 v102, v70 offset:5328
    v_mul_f32 v60, v43, v19
    v_mul_f32 v61, v47, v19
    v_mul_f32 v62, v51, v21
    v_mul_f32 v63, v55, v23
    v_mul_f32 v64, v59, v25
    v_mul_f32 v41, v42, v19
    v_mul_f32 v45, v46, v19
    v_mul_f32 v49, v50, v21
    v_mul_f32 v53, v54, v23
    v_mul_f32 v57, v58, v25
    v_fma_f32 v40, v42, v18, -v60
    v_fma_f32 v44, v46, v18, -v61
    v_fma_f32 v48, v50, v20, -v62
    v_fma_f32 v52, v54, v22, -v63
    v_fma_f32 v56, v58, v24, -v64
    v_fmac_f32 v41, v43, v18
    v_fmac_f32 v45, v47, v18
    v_fmac_f32 v49, v51, v20
    v_fmac_f32 v53, v55, v22
    v_fmac_f32 v57, v59, v24
    v_cvt_pk_bf16_f32 v66, v40, v41
    ds_write_b32 v102, v66 offset:864
    v_cvt_pk_bf16_f32 v67, v44, v45
    ds_write_b32 v102, v67 offset:2016
    v_cvt_pk_bf16_f32 v68, v48, v49
    ds_write_b32 v102, v68 offset:3168
    v_cvt_pk_bf16_f32 v69, v52, v53
    ds_write_b32 v102, v69 offset:4320
    v_cvt_pk_bf16_f32 v70, v56, v57
    ds_write_b32 v102, v70 offset:5472
    v_mul_f32 v60, v41, v19
    v_mul_f32 v61, v45, v19
    v_mul_f32 v62, v49, v21
    v_mul_f32 v63, v53, v23
    v_mul_f32 v64, v57, v25
    v_mul_f32 v43, v40, v19
    v_mul_f32 v47, v44, v19
    v_mul_f32 v51, v48, v21
    v_mul_f32 v55, v52, v23
    v_mul_f32 v59, v56, v25
    v_fma_f32 v42, v40, v18, -v60
    v_fma_f32 v46, v44, v18, -v61
    v_fma_f32 v50, v48, v20, -v62
    v_fma_f32 v54, v52, v22, -v63
    v_fma_f32 v58, v56, v24, -v64
    v_fmac_f32 v43, v41, v18
    v_fmac_f32 v47, v45, v18
    v_fmac_f32 v51, v49, v20
    v_fmac_f32 v55, v53, v22
    v_fmac_f32 v59, v57, v24
    v_cvt_pk_bf16_f32 v66, v42, v43
    ds_write_b32 v102, v66 offset:1008
    v_cvt_pk_bf16_f32 v67, v46, v47
    ds_write_b32 v102, v67 offset:2160
    v_cvt_pk_bf16_f32 v68, v50, v51
    ds_write_b32 v102, v68 offset:3312
    v_cvt_pk_bf16_f32 v69, v54, v55
    ds_write_b32 v102, v69 offset:4464
    v_cvt_pk_bf16_f32 v70, v58, v59
    ds_write_b32 v102, v70 offset:5616
    v_mul_f32 v64, v59, v25
    v_mul_f32 v57, v58, v25
    v_fma_f32 v56, v58, v24, -v64
    v_fmac_f32 v57, v59, v24
    v_cvt_pk_bf16_f32 v70, v56, v57
    ds_write_b32 v102, v70 offset:5760
    s_branch Ldone_fused_kernel_3
Lrole_fused_kernel_2:
    s_setprio 1
    v_mul_f32 v12, 0x3f800000, v4
    v_mul_f32 v13, 0x3f800000, v5
    v_exp_f32 v12, v12
    v_fract_f32 v13, v13
    v_cos_f32 v16, v13
    v_sin_f32 v17, v13
    v_mul_f32 v16, v16, v12
    v_mul_f32 v17, v17, v12
    v_mul_f32 v14, 0x41800000, v4
    v_mul_f32 v15, 0x41800000, v5
    v_exp_f32 v14, v14
    v_fract_f32 v15, v15
    v_cos_f32 v18, v15
    v_sin_f32 v19, v15
    v_mul_f32 v18, v18, v14
    v_mul_f32 v19, v19, v14
    v_mov_b32 v11, 0x3f80
    ds_write_b32 v102, v11 offset:0
    v_cvt_pk_bf16_f32 v96, v16, -v17
    ds_write_b32 v102, v96 offset:144
    v_cvt_pk_bf16_f32 v97, v18, -v19
    ds_write_b32 v102, v97 offset:2304
    v_mul_f32 v6, v17, v17
    v_mul_f32 v7, v19, v19
    v_mul_f32 v21, v16, v17
    v_mul_f32 v23, v18, v19
    v_fma_f32 v20, v16, v16, -v6
    v_fma_f32 v22, v18, v18, -v7
    v_add_f32 v21, v21, v21
    v_add_f32 v23, v23, v23
    v_cvt_pk_bf16_f32 v98, v20, -v21
    ds_write_b32 v102, v98 offset:288
    v_cvt_pk_bf16_f32 v99, v22, -v23
    ds_write_b32 v102, v99 offset:3456
    v_mul_f32 v6, v21, v21
    v_mul_f32 v7, v21, v17
    v_mul_f32 v8, v23, v23
    v_mul_f32 v25, v20, v21
    v_mul_f32 v27, v20, v17
    v_mul_f32 v29, v22, v23
    v_fma_f32 v24, v20, v20, -v6
    v_fma_f32 v26, v20, v16, -v7
    v_fma_f32 v28, v22, v22, -v8
    v_add_f32 v25, v25, v25
    v_fmac_f32 v27, v21, v16
    v_add_f32 v29, v29, v29
    v_cvt_pk_bf16_f32 v96, v24, -v25
    ds_write_b32 v102, v96 offset:576
    v_cvt_pk_bf16_f32 v97, v26, -v27
    ds_write_b32 v102, v97 offset:432
    v_cvt_pk_bf16_f32 v98, v28, -v29
    ds_write_b32 v102, v98 offset:4608
    v_mul_f32 v6, v25, v25
    v_mul_f32 v7, v25, v17
    v_mul_f32 v8, v25, v21
    v_mul_f32 v9, v25, v27
    v_mul_f32 v31, v24, v25
    v_mul_f32 v33, v24, v17
    v_mul_f32 v35, v24, v21
    v_mul_f32 v37, v24, v27
    v_fma_f32 v30, v24, v24, -v6
    v_fma_f32 v32, v24, v16, -v7
    v_fma_f32 v34, v24, v20, -v8
    v_fma_f32 v36, v24, v26, -v9
    v_add_f32 v31, v31, v31
    v_fmac_f32 v33, v25, v16
    v_fmac_f32 v35, v25, v20
    v_fmac_f32 v37, v25, v26
    v_cvt_pk_bf16_f32 v99, v30, -v31
    ds_write_b32 v102, v99 offset:1152
    v_cvt_pk_bf16_f32 v96, v32, -v33
    ds_write_b32 v102, v96 offset:720
    v_cvt_pk_bf16_f32 v97, v34, -v35
    ds_write_b32 v102, v97 offset:864
    v_cvt_pk_bf16_f32 v98, v36, -v37
    ds_write_b32 v102, v98 offset:1008
    v_mul_f32 v6, v31, v17
    v_mul_f32 v7, v31, v21
    v_mul_f32 v8, v31, v27
    v_mul_f32 v9, v31, v25
    v_mul_f32 v12, v31, v33
    v_mul_f32 v13, v31, v35
    v_mul_f32 v14, v31, v37
    v_mul_f32 v39, v30, v17
    v_mul_f32 v41, v30, v21
    v_mul_f32 v43, v30, v27
    v_mul_f32 v45, v30, v25
    v_mul_f32 v47, v30, v33
    v_mul_f32 v49, v30, v35
    v_mul_f32 v51, v30, v37
    v_fma_f32 v38, v30, v16, -v6
    v_fma_f32 v40, v30, v20, -v7
    v_fma_f32 v42, v30, v26, -v8
    v_fma_f32 v44, v30, v24, -v9
    v_fma_f32 v46, v30, v32, -v12
    v_fma_f32 v48, v30, v34, -v13
    v_fma_f32 v50, v30, v36, -v14
    v_fmac_f32 v39, v31, v16
    v_fmac_f32 v41, v31, v20
    v_fmac_f32 v43, v31, v26
    v_fmac_f32 v45, v31, v24
    v_fmac_f32 v47, v31, v32
    v_fmac_f32 v49, v31, v34
    v_fmac_f32 v51, v31, v36
    v_cvt_pk_bf16_f32 v99, v38, -v39
    ds_write_b32 v102, v99 offset:1296
    v_cvt_pk_bf16_f32 v96, v40, -v41
    ds_write_b32 v102, v96 offset:1440
    v_cvt_pk_bf16_f32 v97, v42, -v43
    ds_write_b32 v102, v97 offset:1584
    v_cvt_pk_bf16_f32 v98, v44, -v45
    ds_write_b32 v102, v98 offset:1728
    v_cvt_pk_bf16_f32 v99, v46, -v47
    ds_write_b32 v102, v99 offset:1872
    v_cvt_pk_bf16_f32 v96, v48, -v49
    ds_write_b32 v102, v96 offset:2016
    v_cvt_pk_bf16_f32 v97, v50, -v51
    ds_write_b32 v102, v97 offset:2160
    v_mul_f32 v6, v19, v21
    v_mul_f32 v7, v19, v25
    v_mul_f32 v8, v19, v35
    v_mul_f32 v9, v19, v31
    v_mul_f32 v12, v19, v41
    v_mul_f32 v13, v19, v45
    v_mul_f32 v14, v19, v49
    v_mul_f32 v53, v18, v21
    v_mul_f32 v55, v18, v25
    v_mul_f32 v57, v18, v35
    v_mul_f32 v59, v18, v31
    v_mul_f32 v61, v18, v41
    v_mul_f32 v63, v18, v45
    v_mul_f32 v65, v18, v49
    v_fma_f32 v52, v18, v20, -v6
    v_fma_f32 v54, v18, v24, -v7
    v_fma_f32 v56, v18, v34, -v8
    v_fma_f32 v58, v18, v30, -v9
    v_fma_f32 v60, v18, v40, -v12
    v_fma_f32 v62, v18, v44, -v13
    v_fma_f32 v64, v18, v48, -v14
    v_fmac_f32 v53, v19, v20
    v_fmac_f32 v55, v19, v24
    v_fmac_f32 v57, v19, v34
    v_fmac_f32 v59, v19, v30
    v_fmac_f32 v61, v19, v40
    v_fmac_f32 v63, v19, v44
    v_fmac_f32 v65, v19, v48
    v_cvt_pk_bf16_f32 v98, v52, -v53
    ds_write_b32 v102, v98 offset:2448
    v_cvt_pk_bf16_f32 v99, v54, -v55
    ds_write_b32 v102, v99 offset:2592
    v_cvt_pk_bf16_f32 v96, v56, -v57
    ds_write_b32 v102, v96 offset:2736
    v_cvt_pk_bf16_f32 v97, v58, -v59
    ds_write_b32 v102, v97 offset:2880
    v_cvt_pk_bf16_f32 v98, v60, -v61
    ds_write_b32 v102, v98 offset:3024
    v_cvt_pk_bf16_f32 v99, v62, -v63
    ds_write_b32 v102, v99 offset:3168
    v_cvt_pk_bf16_f32 v96, v64, -v65
    ds_write_b32 v102, v96 offset:3312
    v_mul_f32 v6, v23, v25
    v_mul_f32 v7, v23, v31
    v_mul_f32 v8, v23, v45
    v_mul_f32 v9, v23, v19
    v_mul_f32 v12, v23, v55
    v_mul_f32 v13, v23, v59
    v_mul_f32 v14, v23, v63
    v_mul_f32 v67, v22, v25
    v_mul_f32 v69, v22, v31
    v_mul_f32 v71, v22, v45
    v_mul_f32 v73, v22, v19
    v_mul_f32 v75, v22, v55
    v_mul_f32 v77, v22, v59
    v_mul_f32 v79, v22, v63
    v_fma_f32 v66, v22, v24, -v6
    v_fma_f32 v68, v22, v30, -v7
    v_fma_f32 v70, v22, v44, -v8
    v_fma_f32 v72, v22, v18, -v9
    v_fma_f32 v74, v22, v54, -v12
    v_fma_f32 v76, v22, v58, -v13
    v_fma_f32 v78, v22, v62, -v14
    v_fmac_f32 v67, v23, v24
    v_fmac_f32 v69, v23, v30
    v_fmac_f32 v71, v23, v44
    v_fmac_f32 v73, v23, v18
    v_fmac_f32 v75, v23, v54
    v_fmac_f32 v77, v23, v58
    v_fmac_f32 v79, v23, v62
    v_cvt_pk_bf16_f32 v97, v66, -v67
    ds_write_b32 v102, v97 offset:3600
    v_cvt_pk_bf16_f32 v98, v68, -v69
    ds_write_b32 v102, v98 offset:3744
    v_cvt_pk_bf16_f32 v99, v70, -v71
    ds_write_b32 v102, v99 offset:3888
    v_cvt_pk_bf16_f32 v96, v72, -v73
    ds_write_b32 v102, v96 offset:4032
    v_cvt_pk_bf16_f32 v97, v74, -v75
    ds_write_b32 v102, v97 offset:4176
    v_cvt_pk_bf16_f32 v98, v76, -v77
    ds_write_b32 v102, v98 offset:4320
    v_cvt_pk_bf16_f32 v99, v78, -v79
    ds_write_b32 v102, v99 offset:4464
    v_mul_f32 v6, v29, v31
    v_mul_f32 v7, v29, v19
    v_mul_f32 v8, v29, v59
    v_mul_f32 v9, v29, v23
    v_mul_f32 v12, v29, v69
    v_mul_f32 v13, v29, v73
    v_mul_f32 v14, v29, v77
    v_mul_f32 v81, v28, v31
    v_mul_f32 v83, v28, v19
    v_mul_f32 v85, v28, v59
    v_mul_f32 v87, v28, v23
    v_mul_f32 v89, v28, v69
    v_mul_f32 v91, v28, v73
    v_mul_f32 v93, v28, v77
    v_fma_f32 v80, v28, v30, -v6
    v_fma_f32 v82, v28, v18, -v7
    v_fma_f32 v84, v28, v58, -v8
    v_fma_f32 v86, v28, v22, -v9
    v_fma_f32 v88, v28, v68, -v12
    v_fma_f32 v90, v28, v72, -v13
    v_fma_f32 v92, v28, v76, -v14
    v_fmac_f32 v81, v29, v30
    v_fmac_f32 v83, v29, v18
    v_fmac_f32 v85, v29, v58
    v_fmac_f32 v87, v29, v22
    v_fmac_f32 v89, v29, v68
    v_fmac_f32 v91, v29, v72
    v_fmac_f32 v93, v29, v76
    v_cvt_pk_bf16_f32 v96, v80, -v81
    ds_write_b32 v102, v96 offset:4752
    v_cvt_pk_bf16_f32 v97, v82, -v83
    ds_write_b32 v102, v97 offset:4896
    v_cvt_pk_bf16_f32 v98, v84, -v85
    ds_write_b32 v102, v98 offset:5040
    v_cvt_pk_bf16_f32 v99, v86, -v87
    ds_write_b32 v102, v99 offset:5184
    v_cvt_pk_bf16_f32 v96, v88, -v89
    ds_write_b32 v102, v96 offset:5328
    v_cvt_pk_bf16_f32 v97, v90, -v91
    ds_write_b32 v102, v97 offset:5472
    v_cvt_pk_bf16_f32 v98, v92, -v93
    ds_write_b32 v102, v98 offset:5616
Ldone_fused_kernel_3:
    s_setprio 0
    s_and_b32 s28, s6, 3
    v_and_b32 v3, 15, v1
    v_mov_b32 v5, v132
    v_mov_b32 v8, v133
    v_mov_b32 v4, v134
    v_mov_b32 v12, 0
    v_mov_b32 v13, 0
    v_mov_b32 v14, 0
    v_mov_b32 v15, 0
    s_mul_i32 s29, s27, 1344
    s_add_u32 s29, s29, 98560
    s_waitcnt lgkmcnt(0)
    s_barrier
    v_lshrrev_b32 v98, 2, v1
    s_lshl_b32 s3, s6, 5
    v_add_u32 v98, s3, v98
    v_lshlrev_b32 v2, 14, v98
    v_and_b32 v99, 3, v1
    v_lshl_add_u32 v2, v99, 4, v2
    s_lshl_b32 s33, s25, 5
    s_add_u32 s33, s33, 0
    s_add_u32 s18, s33, 262144
    buffer_load_dwordx4 v[84:87], v2, s[8:11], s33 offen sc1
    buffer_load_dwordx4 v[88:91], v2, s[8:11], s18 offen sc1
    ds_read_b128 v[16:19], v5 offset:0
    ds_read_b128 v[20:23], v8 offset:24576
    ds_read_b128 v[24:27], v5 offset:16
    ds_read_b128 v[28:31], v8 offset:24592
    ds_read_b128 v[32:35], v5 offset:32
    ds_read_b128 v[36:39], v8 offset:24608
    ds_read_b128 v[40:43], v5 offset:48
    ds_read_b128 v[44:47], v8 offset:24624
    ds_read_b128 v[48:51], v5 offset:64
    ds_read_b128 v[52:55], v8 offset:24640
    ds_read_b128 v[56:59], v5 offset:80
    ds_read_b128 v[60:63], v8 offset:24656
    ds_read_b128 v[64:67], v5 offset:96
    ds_read_b128 v[68:71], v8 offset:24672
    ds_read_b128 v[72:75], v5 offset:112
    ds_read_b128 v[76:79], v8 offset:24688
    s_waitcnt lgkmcnt(14)
    v_mfma_f32_16x16x32_bf16 v[12:15], v[16:19], v[20:23], v[12:15]
    s_waitcnt lgkmcnt(12)
    v_mfma_f32_16x16x32_bf16 v[12:15], v[24:27], v[28:31], v[12:15]
    s_waitcnt lgkmcnt(10)
    v_mfma_f32_16x16x32_bf16 v[12:15], v[32:35], v[36:39], v[12:15]
    s_waitcnt lgkmcnt(8)
    v_mfma_f32_16x16x32_bf16 v[12:15], v[40:43], v[44:47], v[12:15]
    s_waitcnt lgkmcnt(6)
    v_mfma_f32_16x16x32_bf16 v[12:15], v[48:51], v[52:55], v[12:15]
    s_waitcnt lgkmcnt(4)
    v_mfma_f32_16x16x32_bf16 v[12:15], v[56:59], v[60:63], v[12:15]
    s_waitcnt lgkmcnt(2)
    v_mfma_f32_16x16x32_bf16 v[12:15], v[64:67], v[68:71], v[12:15]
    s_waitcnt lgkmcnt(0)
    v_mfma_f32_16x16x32_bf16 v[12:15], v[72:75], v[76:79], v[12:15]
    s_nop 7
    v_cvt_pk_bf16_f32 v16, v12, v12
    v_cvt_pk_bf16_f32 v17, v13, v13
    v_cvt_pk_bf16_f32 v18, v14, v14
    v_cvt_pk_bf16_f32 v19, v15, v15
    s_cmp_eq_u32 s28, 0
    s_cbranch_scc1 Lr0_fused_kernel_4
    s_mov_b32 exec_lo, 0
Lr0_fused_kernel_4:
    ds_write_b16 v4, v16 offset:0
    ds_write_b16 v4, v17 offset:32
    ds_write_b16 v4, v18 offset:64
    ds_write_b16 v4, v19 offset:96
    s_mov_b64 exec, 1
    v_mov_b32 v5, s29
    s_cmp_eq_u32 s28, 3
    s_cbranch_scc0 Lr3_fused_kernel_5
    ds_write_b16 v5, v16 offset:1280
Lr3_fused_kernel_5:
    s_cmp_eq_u32 s28, 0
    s_cbranch_scc0 Lrx_fused_kernel_6
    ds_write_b16 v5, v104 offset:1282
Lrx_fused_kernel_6:
    s_mov_b64 exec, -1
    s_waitcnt lgkmcnt(0)
    s_barrier
    ds_read_u16 v16, v108
    ds_read_u16 v17, v109
    ds_read_u16 v18, v110
    ds_read_u16 v19, v111
    ds_read_u16 v20, v112
    ds_read_u16 v21, v113
    ds_read_u16 v22, v114
    ds_read_u16 v23, v115
    ds_read_u16 v24, v116
    ds_read_u16 v25, v117
    ds_read_u16 v26, v118
    v_lshrrev_b32 v3, 8, v0
    v_mul_u32_u24 v3, 16640, v3
    v_and_b32 v4, 255, v0
    v_lshlrev_b32 v4, 4, v4
    v_add_u32 v3, v3, v4
    v_add_u32 v3, 256, v3
    v_bfe_u32 v5, v0, 4, 1
    v_mul_u32_u24 v5, 16640, v5
    v_bfe_u32 v6, v0, 2, 2
    v_mul_u32_u24 v6, 4160, v6
    v_and_b32 v7, 3, v0
    v_lshlrev_b32 v7, 4, v7
    v_add3_u32 v5, v5, v6, v7
    v_cmp_gt_u32 vcc, 32, v0
    s_and_saveexec_b64 s[30:31], vcc
    ds_write_b128 v5, v[104:107] offset:4352
    s_mov_b64 exec, s[30:31]
    s_waitcnt lgkmcnt(0)
    v_lshl_or_b32 v32, v17, 16, v16
    v_lshl_or_b32 v33, v19, 16, v18
    v_lshl_or_b32 v34, v21, 16, v20
    v_lshl_or_b32 v35, v23, 16, v22
    ds_write_b128 v3, v[32:35] offset:0
    v_lshl_or_b32 v36, v18, 16, v17
    v_lshl_or_b32 v37, v20, 16, v19
    v_lshl_or_b32 v38, v22, 16, v21
    v_lshl_or_b32 v39, v24, 16, v23
    ds_write_b128 v3, v[36:39] offset:4160
    v_lshl_or_b32 v40, v19, 16, v18
    v_lshl_or_b32 v41, v21, 16, v20
    v_lshl_or_b32 v42, v23, 16, v22
    v_lshl_or_b32 v43, v25, 16, v24
    ds_write_b128 v3, v[40:43] offset:8320
    v_lshl_or_b32 v44, v20, 16, v19
    v_lshl_or_b32 v45, v22, 16, v21
    v_lshl_or_b32 v46, v24, 16, v23
    v_lshl_or_b32 v47, v26, 16, v25
    ds_write_b128 v3, v[44:47] offset:12480
    v_and_b32 v3, 3, v98
    v_mul_u32_u24 v3, 1552, v3
    v_lshrrev_b32 v4, 2, v98
    v_add_u32 v4, 32, v4
    v_lshlrev_b32 v4, 4, v4
    v_and_b32 v5, 1, v99
    v_mul_u32_u24 v5, 6272, v5
    v_add3_u32 v3, v3, v4, v5
    v_lshrrev_b32 v5, 1, v99
    v_lshl_add_u32 v3, v5, 3, v3
    v_add_u32 v3, 101632, v3
    v_and_b32 v10, 31, v1
    v_lshrrev_b32 v11, 5, v1
    v_sub_u32 v5, 3, v10
    v_and_b32 v5, 3, v5
    v_lshlrev_b32 v6, 3, v11
    v_sub_u32 v6, v6, v10
    v_sub_u32 v6, v6, v5
    v_add_u32 v6, 2047, v6
    v_lshlrev_b32 v6, 1, v6
    v_mul_u32_u24 v5, 4160, v5
    v_add_u32 v6, v6, v5
    s_mul_i32 s29, s27, 16640
    s_add_u32 s29, s29, 256
    v_add_u32 v6, s29, v6
    v_mul_u32_u24 v7, 1552, v11
    v_lshlrev_b32 v8, 4, v10
    v_add_u32 v7, v7, v8
    s_mul_i32 s29, s27, 6272
    s_add_u32 s29, s29, 102144
    v_add_u32 v7, s29, v7
    s_mul_i32 s30, s28, 12
    s_cmp_eq_u32 s28, 3
    s_cselect_b32 s30, 40, s30
    s_mov_b32 s31, 12
    s_cmp_eq_u32 s28, 2
    s_cselect_b32 s31, 8, s31
    s_cmp_eq_u32 s28, 3
    s_cselect_b32 s31, 0, s31
    s_mov_b32 s32, 0
    s_cmp_eq_u32 s28, 2
    s_cselect_b32 s32, 8, s32
    s_cmp_eq_u32 s28, 3
    s_cselect_b32 s32, 24, s32
    s_add_u32 s34, s30, 2
    s_lshl_b32 s35, s34, 6
    v_subrev_u32 v6, s35, v6
    s_lshl_b32 s35, s34, 4
    v_subrev_u32 v7, s35, v7
    v_mov_b32 v64, 0
    v_mov_b32 v65, 0
    v_mov_b32 v66, 0
    v_mov_b32 v67, 0
    v_mov_b32 v68, 0
    v_mov_b32 v69, 0
    v_mov_b32 v70, 0
    v_mov_b32 v71, 0
    v_mov_b32 v72, 0
    v_mov_b32 v73, 0
    v_mov_b32 v74, 0
    v_mov_b32 v75, 0
    v_mov_b32 v76, 0
    v_mov_b32 v77, 0
    v_mov_b32 v78, 0
    v_mov_b32 v79, 0
    v_mov_b32 v80, 0
    v_mov_b32 v81, 0
    v_mov_b32 v82, 0
    v_mov_b32 v83, 0
    s_mov_b32 s7, 0
    s_waitcnt vmcnt(0)
    v_xor_b32 v92, s20, v86
    v_xor_b32 v93, s22, v87
    v_xor_b32 v94, s20, v90
    v_xor_b32 v95, s22, v91
    v_or3_b32 v92, v92, v93, v94
    v_or_b32 v92, v92, v95
    v_cmp_ne_u32 vcc, 0, v92
    s_cbranch_vccz Ltagc_fused_kernel_9
    s_mov_b64 exec, vcc
Ltag_fused_kernel_7:
    buffer_load_dwordx4 v[84:87], v2, s[8:11], s33 offen sc1
    s_add_u32 s3, s33, 262144
    buffer_load_dwordx4 v[88:91], v2, s[8:11], s3 offen sc1
    s_add_u32 s7, s7, 1
    s_bitcmp1_b32 s7, 17
    s_cbranch_scc1 Ltagx_fused_kernel_8
    s_waitcnt vmcnt(0)
    s_mov_b64 exec, -1
    v_xor_b32 v92, s20, v86
    v_xor_b32 v93, s22, v87
    v_xor_b32 v94, s20, v90
    v_xor_b32 v95, s22, v91
    v_or3_b32 v92, v92, v93, v94
    v_or_b32 v92, v92, v95
    v_cmp_ne_u32 vcc, 0, v92
    s_mov_b64 exec, vcc
    s_cbranch_vccnz Ltag_fused_kernel_7
Ltagx_fused_kernel_8:
    s_mov_b64 exec, -1
    s_waitcnt vmcnt(0)
Ltagc_fused_kernel_9:
    v_mov_b32 v100, v84
    v_mov_b32 v101, v85
    v_mov_b32 v102, v88
    v_mov_b32 v103, v89
    ds_write_b64 v3, v[100:101]
    ds_write_b64 v3, v[102:103] offset:64
    v_mov_b32 v84, 0
    v_mov_b32 v85, 0
    v_mov_b32 v86, 0
    v_mov_b32 v87, 0
    v_mov_b32 v88, 0
    v_mov_b32 v89, 0
    v_mov_b32 v90, 0
    v_mov_b32 v91, 0
    v_mov_b32 v92, 0
    v_mov_b32 v93, 0
    v_mov_b32 v94, 0
    v_mov_b32 v95, 0
    v_lshlrev_b32 v103, 4, v0
    s_lshl_b32 s3, s24, 13
    s_add_u32 s3, s3, 12582912
    buffer_store_dwordx4 v[128:131], v103, s[8:11], s3 offen sc1
    v_lshlrev_b32 v103, 4, v1
    s_lshl_b32 s3, s71, 3
    s_add_u32 s3, s3, s6
    s_lshl_b32 s3, s3, 13
    s_lshl_b32 s7, s70, 10
    s_add_u32 s3, s3, s7
    s_add_u32 s3, s3, 14680064
    s_lshl_b32 s7, s2, 13
    s_add_u32 s7, s7, 17825792
    s_cmp_eq_u32 s73, 7
    s_cselect_b32 s3, s7, s3
    buffer_store_dwordx4 v[128:131], v103, s[8:11], s3 offen sc1
    s_sub_u32 s3, s6, 4
    s_cmp_le_u32 s3, 1
    s_cselect_b64 exec, -1, 1
    s_cselect_b32 s3, s3, 0
    s_add_u32 s3, s3, 0
    s_lshl_b32 s3, s3, 6
    s_lshr_b32 s3, s3, 2
    s_lshr_b32 s7, s5, 2
    s_mul_i32 s7, s7, 224
    s_add_u32 s3, s3, s7
    s_and_b32 s7, s5, 3
    s_lshl_b32 s7, s7, 5
    s_add_u32 s3, s3, s7
    v_lshrrev_b32 v119, 2, v1
    v_add_u32 v119, s3, v119
    v_mul_u32_u24 v119, 4096, v119
    v_and_b32 v103, 3, v1
    v_lshl_add_u32 v119, v103, 7, v119
    s_lshl_b32 s3, s4, 2
    s_lshl_b32 s3, s3, 7
    v_add_u32 v119, s3, v119
    global_load_dword v254, v119, s[60:61]
    s_mov_b64 exec, -1
    s_waitcnt lgkmcnt(0)
    s_barrier
    s_cmp_eq_u32 s31, 0
    s_cbranch_scc1 Lcx_fused_kernel_11
    ds_read_b64 v[16:17], v6 offset:128
    ds_read_b64 v[18:19], v6 offset:136
    ds_read_b128 v[32:35], v7 offset:32
    ds_read_b128 v[40:43], v7 offset:544
    ds_read_b64 v[20:21], v6 offset:160
    ds_read_b64 v[22:23], v6 offset:168
    ds_read_b128 v[36:39], v7 offset:3136
    ds_read_b128 v[44:47], v7 offset:3648
Lcv_fused_kernel_10:
    s_waitcnt lgkmcnt(5)
    v_mfma_f32_32x32x16_bf16 v[64:79], v[16:19], v[32:35], v[64:79]
    ds_read_b64 v[24:25], v6 offset:64
    ds_read_b64 v[26:27], v6 offset:72
    s_waitcnt lgkmcnt(6)
    v_mfma_f32_32x32x16_bf16 v[80:95], v[16:19], v[40:43], v[80:95]
    ds_read_b128 v[48:51], v7 offset:16
    ds_read_b128 v[56:59], v7 offset:528
    s_waitcnt lgkmcnt(5)
    v_mfma_f32_32x32x16_bf16 v[64:79], v[20:23], v[36:39], v[64:79]
    ds_read_b64 v[28:29], v6 offset:96
    ds_read_b64 v[30:31], v6 offset:104
    s_waitcnt lgkmcnt(6)
    v_mfma_f32_32x32x16_bf16 v[80:95], v[20:23], v[44:47], v[80:95]
    ds_read_b128 v[52:55], v7 offset:3120
    ds_read_b128 v[60:63], v7 offset:3632
    s_waitcnt lgkmcnt(5)
    v_mfma_f32_32x32x16_bf16 v[64:79], v[24:27], v[48:51], v[64:79]
    ds_read_b64 v[16:17], v6 offset:0
    ds_read_b64 v[18:19], v6 offset:8
    s_waitcnt lgkmcnt(6)
    v_mfma_f32_32x32x16_bf16 v[80:95], v[24:27], v[56:59], v[80:95]
    ds_read_b128 v[32:35], v7 offset:0
    ds_read_b128 v[40:43], v7 offset:512
    s_waitcnt lgkmcnt(5)
    v_mfma_f32_32x32x16_bf16 v[64:79], v[28:31], v[52:55], v[64:79]
    ds_read_b64 v[20:21], v6 offset:32
    ds_read_b64 v[22:23], v6 offset:40
    s_waitcnt lgkmcnt(6)
    v_mfma_f32_32x32x16_bf16 v[80:95], v[28:31], v[60:63], v[80:95]
    ds_read_b128 v[36:39], v7 offset:3104
    ds_read_b128 v[44:47], v7 offset:3616
    v_subrev_u32 v6, 128, v6
    v_subrev_u32 v7, 32, v7
    s_sub_u32 s31, s31, 2
    s_cmp_lg_u32 s31, 0
    s_cbranch_scc1 Lcv_fused_kernel_10
    s_waitcnt lgkmcnt(0)
Lcx_fused_kernel_11:
    s_cmp_eq_u32 s32, 0
    s_cbranch_scc1 Lcx_fused_kernel_13
    ds_read_b64 v[16:17], v6 offset:128
    ds_read_b64 v[18:19], v6 offset:136
    ds_read_b128 v[40:43], v7 offset:544
    ds_read_b64 v[20:21], v6 offset:160
    ds_read_b64 v[22:23], v6 offset:168
    ds_read_b128 v[44:47], v7 offset:3648
Lcv_fused_kernel_12:
    s_waitcnt lgkmcnt(3)
    v_mfma_f32_32x32x16_bf16 v[80:95], v[16:19], v[40:43], v[80:95]
    ds_read_b64 v[24:25], v6 offset:64
    ds_read_b64 v[26:27], v6 offset:72
    ds_read_b128 v[56:59], v7 offset:528
    s_waitcnt lgkmcnt(3)
    v_mfma_f32_32x32x16_bf16 v[80:95], v[20:23], v[44:47], v[80:95]
    ds_read_b64 v[28:29], v6 offset:96
    ds_read_b64 v[30:31], v6 offset:104
    ds_read_b128 v[60:63], v7 offset:3632
    s_waitcnt lgkmcnt(3)
    v_mfma_f32_32x32x16_bf16 v[80:95], v[24:27], v[56:59], v[80:95]
    ds_read_b64 v[16:17], v6 offset:0
    ds_read_b64 v[18:19], v6 offset:8
    ds_read_b128 v[40:43], v7 offset:512
    s_waitcnt lgkmcnt(3)
    v_mfma_f32_32x32x16_bf16 v[80:95], v[28:31], v[60:63], v[80:95]
    ds_read_b64 v[20:21], v6 offset:32
    ds_read_b64 v[22:23], v6 offset:40
    ds_read_b128 v[44:47], v7 offset:3616
    v_subrev_u32 v6, 128, v6
    v_subrev_u32 v7, 32, v7
    s_sub_u32 s32, s32, 2
    s_cmp_lg_u32 s32, 0
    s_cbranch_scc1 Lcv_fused_kernel_12
    s_waitcnt lgkmcnt(0)
Lcx_fused_kernel_13:
    s_waitcnt vmcnt(1)
    s_mov_b64 exec, 1
    v_mov_b32 v100, 163776
    v_mov_b32 v101, 1
    ds_add_rtn_u32 v100, v100, v101
    s_waitcnt lgkmcnt(0)
    v_readfirstlane_b32 s7, v100
    s_mov_b64 exec, -1
    s_cmp_eq_u32 s7, 7
    s_cbranch_scc0 Larr_fused_kernel_14
    v_lshlrev_b32 v100, 10, v1
    s_lshl_b32 s7, s2, 2
    s_add_u32 s7, s7, 16842752
    v_mov_b32 v101, s20
    s_mov_b64 exec, 65535
    buffer_store_dword v101, v100, s[8:11], s7 offen sc1
    s_mov_b64 exec, -1
Larr_fused_kernel_14:
    v_mul_u32_u24 v8, 144, v10
    v_lshlrev_b32 v9, 4, v11
    v_add_u32 v8, v8, v9
    s_mul_i32 s29, s27, 32256
    s_mul_i32 s30, s28, 4608
    s_add_u32 s29, s29, s30
    s_add_u32 s29, s29, 33664
    v_add_u32 v8, s29, v8
    v_lshrrev_b32 v3, 2, v1
    s_lshl_b32 s29, s6, 4
    v_add_u32 v3, s29, v3
    v_lshrrev_b32 v4, 2, v3
    v_mul_u32_u24 v4, 144, v4
    v_and_b32 v3, 3, v3
    v_lshl_add_u32 v3, v3, 5, v4
    v_and_b32 v4, 1, v1
    v_lshl_add_u32 v3, v4, 4, v3
    v_bfe_u32 v4, v1, 1, 1
    v_mul_u32_u24 v4, 32256, v4
    v_add_u32 v3, v3, v4
    v_add_u32 v3, 33664, v3
    s_cmp_eq_u32 s28, 3
    s_cbranch_scc1 Lp3_fused_kernel_15
    ds_write_b128 v8, v[64:67] offset:0
    ds_write_b128 v8, v[68:71] offset:32
    ds_write_b128 v8, v[72:75] offset:64
    ds_write_b128 v8, v[76:79] offset:96
Lp3_fused_kernel_15:
    ds_write_b128 v8, v[80:83] offset:13824
    ds_write_b128 v8, v[84:87] offset:13856
    ds_write_b128 v8, v[88:91] offset:13888
    ds_write_b128 v8, v[92:95] offset:13920
    s_waitcnt lgkmcnt(0)
    s_barrier
    ds_read_b128 v[16:19], v3 offset:0
    ds_read_b128 v[20:23], v3 offset:4608
    ds_read_b128 v[24:27], v3 offset:9216
    ds_read_b128 v[28:31], v3 offset:13824
    ds_read_b128 v[32:35], v3 offset:18432
    ds_read_b128 v[36:39], v3 offset:23040
    ds_read_b128 v[40:43], v3 offset:27648
    v_lshlrev_b32 v3, 4, v1
    s_lshl_b32 s29, s25, 13
    s_lshl_b32 s30, s6, 10
    s_add_u32 s29, s29, s30
    s_add_u32 s29, s29, 4194304
    s_add_u32 s30, s29, 8192
    v_mov_b32 v50, s20
    v_mov_b32 v51, s22
    v_mov_b32 v54, s20
    v_mov_b32 v55, s22
    s_waitcnt lgkmcnt(0)
    v_add_f32 v16, v16, v20
    v_add_f32 v28, v28, v32
    v_add_f32 v36, v36, v40
    v_add_f32 v17, v17, v21
    v_add_f32 v29, v29, v33
    v_add_f32 v37, v37, v41
    v_add_f32 v18, v18, v22
    v_add_f32 v30, v30, v34
    v_add_f32 v38, v38, v42
    v_add_f32 v19, v19, v23
    v_add_f32 v31, v31, v35
    v_add_f32 v39, v39, v43
    v_add_f32 v16, v16, v24
    v_add_f32 v28, v28, v36
    v_add_f32 v17, v17, v25
    v_add_f32 v29, v29, v37
    v_add_f32 v18, v18, v26
    v_add_f32 v30, v30, v38
    v_add_f32 v19, v19, v27
    v_add_f32 v31, v31, v39
    v_cvt_pk_bf16_f32 v48, v16, v17
    v_cvt_pk_bf16_f32 v49, v18, v19
    v_cvt_pk_bf16_f32 v52, v28, v29
    v_cvt_pk_bf16_f32 v53, v30, v31
    buffer_store_dwordx4 v[48:51], v3, s[8:11], s29 offen sc1
    buffer_store_dwordx4 v[52:55], v3, s[8:11], s30 offen sc1
    s_barrier
    s_cmp_eq_u32 s73, 7
    s_cbranch_scc1 Lact_fused_kernel_17
    s_mov_b32 s12, s56
    s_mov_b32 s13, s57
    s_mov_b32 s14, 7340032
    s_mov_b32 s15, 0x20000
    v_lshrrev_b32 v3, 3, v1
    v_and_b32 v4, 7, v1
    v_bfe_u32 v5, v3, 1, 1
    v_lshlrev_b32 v5, 2, v5
    v_xor_b32 v4, v4, v5
    v_mul_u32_u24 v3, 3584, v3
    v_lshl_add_u32 v112, v4, 4, v3
    s_mul_i32 s27, s6, 917504
    s_lshl_b32 s3, s71, 7
    s_add_u32 s27, s27, s3
    v_lshrrev_b32 v4, 4, v1
    v_bfe_u32 v5, v1, 2, 2
    v_and_b32 v6, 3, v1
    v_lshrrev_b32 v7, 1, v4
    v_lshl_add_u32 v7, v7, 3, v5
    v_lshlrev_b32 v7, 7, v7
    v_and_b32 v8, 1, v4
    v_lshlrev_b32 v8, 1, v8
    v_lshrrev_b32 v9, 1, v6
    v_add_u32 v8, v8, v9
    v_bfe_u32 v9, v5, 1, 1
    v_lshl_add_u32 v8, v9, 2, v8
    v_lshl_add_u32 v7, v8, 4, v7
    v_and_b32 v9, 1, v6
    v_lshl_add_u32 v113, v9, 3, v7
    s_mul_i32 s28, s6, 16384
    v_add_u32 v114, s28, v113
    v_xor_b32 v115, 64, v114
    s_add_u32 s7, s27, 0
    s_add_u32 m0, s28, 0
    s_add_u32 s3, s7, 0
    buffer_load_dwordx4 v112, s[12:15], s3 offen lds
    s_add_u32 m0, s28, 1024
    s_add_u32 s3, s7, 28672
    buffer_load_dwordx4 v112, s[12:15], s3 offen lds
    s_add_u32 m0, s28, 2048
    s_add_u32 s3, s7, 57344
    buffer_load_dwordx4 v112, s[12:15], s3 offen lds
    s_add_u32 m0, s28, 3072
    s_add_u32 s3, s7, 86016
    buffer_load_dwordx4 v112, s[12:15], s3 offen lds
    s_add_u32 s7, s27, 114688
    s_add_u32 m0, s28, 4096
    s_add_u32 s3, s7, 0
    buffer_load_dwordx4 v112, s[12:15], s3 offen lds
    s_add_u32 m0, s28, 5120
    s_add_u32 s3, s7, 28672
    buffer_load_dwordx4 v112, s[12:15], s3 offen lds
    s_add_u32 m0, s28, 6144
    s_add_u32 s3, s7, 57344
    buffer_load_dwordx4 v112, s[12:15], s3 offen lds
    s_add_u32 m0, s28, 7168
    s_add_u32 s3, s7, 86016
    buffer_load_dwordx4 v112, s[12:15], s3 offen lds
    s_add_u32 s7, s27, 229376
    s_add_u32 m0, s28, 8192
    s_add_u32 s3, s7, 0
    buffer_load_dwordx4 v112, s[12:15], s3 offen lds
    s_add_u32 m0, s28, 9216
    s_add_u32 s3, s7, 28672
    buffer_load_dwordx4 v112, s[12:15], s3 offen lds
    s_add_u32 m0, s28, 10240
    s_add_u32 s3, s7, 57344
    buffer_load_dwordx4 v112, s[12:15], s3 offen lds
    s_add_u32 m0, s28, 11264
    s_add_u32 s3, s7, 86016
    buffer_load_dwordx4 v112, s[12:15], s3 offen lds
Lact_fused_kernel_17:
    v_lshrrev_b32 v3, 2, v1
    s_lshl_b32 s29, s6, 4
    v_add_u32 v5, s29, v3
    v_lshlrev_b32 v3, 14, v5
    v_and_b32 v4, 3, v1
    v_lshl_add_u32 v3, v4, 4, v3
    s_lshl_b32 s29, s24, 6
    s_add_u32 s29, s29, 4194304
    v_lshlrev_b32 v8, 16, v120
    v_and_b32 v9, 0xffff0000, v120
    v_lshlrev_b32 v10, 16, v121
    v_and_b32 v11, 0xffff0000, v121
    v_lshlrev_b32 v12, 16, v122
    v_and_b32 v13, 0xffff0000, v122
    v_lshlrev_b32 v14, 16, v123
    v_and_b32 v15, 0xffff0000, v123
    v_lshlrev_b32 v24, 16, v124
    v_and_b32 v25, 0xffff0000, v124
    v_lshlrev_b32 v26, 16, v125
    v_and_b32 v27, 0xffff0000, v125
    v_lshlrev_b32 v28, 16, v126
    v_and_b32 v29, 0xffff0000, v126
    v_lshlrev_b32 v30, 16, v127
    v_and_b32 v31, 0xffff0000, v127
    v_bfe_u32 v36, v1, 1, 1
    v_lshl_add_u32 v36, v5, 1, v36
    v_lshlrev_b32 v36, 2, v36
    v_and_b32 v4, 1, v1
    v_mul_u32_u24 v4, 4224, v4
    v_add_u32 v36, v36, v4
    v_add_u32 v36, 131072, v36
    s_lshr_b32 s30, s6, 1
    s_mul_i32 s30, s30, 2112
    s_add_u32 s30, s30, 131072
    v_lshlrev_b32 v37, 5, v1
    v_add_u32 v37, s30, v37
    s_mul_i32 s7, s6, 1088
    v_lshlrev_b32 v100, 4, v1
    v_add_u32 v100, s7, v100
    v_bfe_u32 v101, v1, 2, 2
    v_mul_u32_u24 v101, 1088, v101
    v_lshrrev_b32 v2, 4, v1
    v_lshl_add_u32 v101, v2, 5, v101
    v_and_b32 v2, 3, v1
    v_lshl_add_u32 v101, v2, 3, v101
    s_lshl_b32 s7, s6, 7
    v_add_u32 v101, s7, v101
    v_add_u32 v100, 139520, v100
    v_add_u32 v101, 139520, v101
    s_mov_b32 s35, 0xffff0000
    s_mov_b32 s7, 0
Ltag_fused_kernel_18:
    buffer_load_dwordx4 v[96:99], v3, s[8:11], s29 offen sc1
    s_add_u32 s3, s29, 2097152
    buffer_load_dwordx4 v[104:107], v3, s[8:11], s3 offen sc1
    s_add_u32 s7, s7, 1
    s_bitcmp1_b32 s7, 17
    s_cbranch_scc1 Ltagx_fused_kernel_19
    s_waitcnt vmcnt(0)
    s_mov_b64 exec, -1
    v_xor_b32 v108, s20, v98
    v_xor_b32 v109, s22, v99
    v_xor_b32 v110, s20, v106
    v_xor_b32 v111, s22, v107
    v_or3_b32 v108, v108, v109, v110
    v_or_b32 v108, v108, v111
    v_cmp_ne_u32 vcc, 0, v108
    s_mov_b64 exec, vcc
    s_cbranch_vccnz Ltag_fused_kernel_18
Ltagx_fused_kernel_19:
    s_mov_b64 exec, -1
    s_waitcnt vmcnt(0)
Ltagc_fused_kernel_20:
    v_mov_b32 v44, v96
    v_mov_b32 v45, v97
    v_mov_b32 v46, v104
    v_mov_b32 v47, v105
    ds_write_b32 v36, v44
    ds_write_b32 v36, v45 offset:2112
    ds_write_b32 v36, v46 offset:1024
    ds_write_b32 v36, v47 offset:3136
    s_cmp_eq_u32 s73, 7
    s_cbranch_scc1 Lact_fused_kernel_21
    s_add_u32 s7, s27, 344064
    s_add_u32 m0, s28, 12288
    s_add_u32 s3, s7, 0
    buffer_load_dwordx4 v112, s[12:15], s3 offen lds
    s_add_u32 m0, s28, 13312
    s_add_u32 s3, s7, 28672
    buffer_load_dwordx4 v112, s[12:15], s3 offen lds
    s_add_u32 m0, s28, 14336
    s_add_u32 s3, s7, 57344
    buffer_load_dwordx4 v112, s[12:15], s3 offen lds
    s_add_u32 m0, s28, 15360
    s_add_u32 s3, s7, 86016
    buffer_load_dwordx4 v112, s[12:15], s3 offen lds
    ds_read_b64_tr_b16 v[128:129], v114 offset:0
    ds_read_b64_tr_b16 v[130:131], v114 offset:512
    ds_read_b64_tr_b16 v[132:133], v115 offset:0
    ds_read_b64_tr_b16 v[134:135], v115 offset:512
    ds_read_b64_tr_b16 v[136:137], v114 offset:2048
    ds_read_b64_tr_b16 v[138:139], v114 offset:2560
    ds_read_b64_tr_b16 v[140:141], v115 offset:2048
    ds_read_b64_tr_b16 v[142:143], v115 offset:2560
    ds_read_b64_tr_b16 v[144:145], v114 offset:4096
    ds_read_b64_tr_b16 v[146:147], v114 offset:4608
    ds_read_b64_tr_b16 v[148:149], v115 offset:4096
    ds_read_b64_tr_b16 v[150:151], v115 offset:4608
    ds_read_b64_tr_b16 v[152:153], v114 offset:6144
    ds_read_b64_tr_b16 v[154:155], v114 offset:6656
    ds_read_b64_tr_b16 v[156:157], v115 offset:6144
    ds_read_b64_tr_b16 v[158:159], v115 offset:6656
    ds_read_b64_tr_b16 v[160:161], v114 offset:8192
    ds_read_b64_tr_b16 v[162:163], v114 offset:8704
    ds_read_b64_tr_b16 v[164:165], v115 offset:8192
    ds_read_b64_tr_b16 v[166:167], v115 offset:8704
    ds_read_b64_tr_b16 v[168:169], v114 offset:10240
    ds_read_b64_tr_b16 v[170:171], v114 offset:10752
    ds_read_b64_tr_b16 v[172:173], v115 offset:10240
    ds_read_b64_tr_b16 v[174:175], v115 offset:10752
Lact_fused_kernel_21:
    s_and_b32 s29, s6, 1
    s_xor_b32 s29, s29, 1
    s_lshl_b32 s29, s29, 4
    s_waitcnt lgkmcnt(0)
    s_barrier
    ds_read_b128 v[52:55], v37
    ds_read_b128 v[56:59], v37 offset:16
    s_cmp_eq_u32 s73, 7
    s_cbranch_scc1 Lact_fused_kernel_22
    s_add_u32 s7, s27, 458752
    s_add_u32 m0, s28, 0
    s_add_u32 s3, s7, 0
    buffer_load_dwordx4 v112, s[12:15], s3 offen lds
    s_add_u32 m0, s28, 1024
    s_add_u32 s3, s7, 28672
    buffer_load_dwordx4 v112, s[12:15], s3 offen lds
    s_add_u32 m0, s28, 2048
    s_add_u32 s3, s7, 57344
    buffer_load_dwordx4 v112, s[12:15], s3 offen lds
    s_add_u32 m0, s28, 3072
    s_add_u32 s3, s7, 86016
    buffer_load_dwordx4 v112, s[12:15], s3 offen lds
Lact_fused_kernel_22:
    s_waitcnt lgkmcnt(0)
    v_lshlrev_b32 v52, s29, v52
    v_and_b32 v52, s35, v52
    v_lshlrev_b32 v53, s29, v53
    v_and_b32 v53, s35, v53
    v_lshlrev_b32 v54, s29, v54
    v_and_b32 v54, s35, v54
    v_lshlrev_b32 v55, s29, v55
    v_and_b32 v55, s35, v55
    v_lshlrev_b32 v56, s29, v56
    v_and_b32 v56, s35, v56
    v_lshlrev_b32 v57, s29, v57
    v_and_b32 v57, s35, v57
    v_lshlrev_b32 v58, s29, v58
    v_and_b32 v58, s35, v58
    v_lshlrev_b32 v59, s29, v59
    v_and_b32 v59, s35, v59
    v_add_f32 v24, v52, v24
    v_add_f32 v25, v53, v25
    v_add_f32 v26, v54, v26
    v_add_f32 v27, v55, v27
    v_add_f32 v28, v56, v28
    v_add_f32 v29, v57, v29
    v_add_f32 v30, v58, v30
    v_add_f32 v31, v59, v31
    v_cvt_pk_bf16_f32 v60, v24, v25
    v_cvt_pk_bf16_f32 v61, v26, v27
    v_cvt_pk_bf16_f32 v62, v28, v29
    v_cvt_pk_bf16_f32 v63, v30, v31
    v_lshlrev_b32 v24, 16, v60
    v_and_b32 v25, 0xffff0000, v60
    v_lshlrev_b32 v26, 16, v61
    v_and_b32 v27, 0xffff0000, v61
    v_lshlrev_b32 v28, 16, v62
    v_and_b32 v29, 0xffff0000, v62
    v_lshlrev_b32 v30, 16, v63
    v_and_b32 v31, 0xffff0000, v63
    v_add_f32 v24, v8, v24
    v_add_f32 v25, v9, v25
    v_add_f32 v26, v10, v26
    v_add_f32 v27, v11, v27
    v_add_f32 v28, v12, v28
    v_add_f32 v29, v13, v29
    v_add_f32 v30, v14, v30
    v_add_f32 v31, v15, v31
    v_cvt_pk_bf16_f32 v60, v24, v25
    v_cvt_pk_bf16_f32 v61, v26, v27
    v_cvt_pk_bf16_f32 v62, v28, v29
    v_cvt_pk_bf16_f32 v63, v30, v31
    v_lshlrev_b32 v8, 16, v60
    v_and_b32 v9, 0xffff0000, v60
    v_lshlrev_b32 v10, 16, v61
    v_and_b32 v11, 0xffff0000, v61
    v_lshlrev_b32 v12, 16, v62
    v_and_b32 v13, 0xffff0000, v62
    v_lshlrev_b32 v14, 16, v63
    v_and_b32 v15, 0xffff0000, v63
    s_cmp_eq_u32 s73, 7
    s_cbranch_scc1 Lact_fused_kernel_23
    s_add_u32 s7, s27, 573440
    s_add_u32 m0, s28, 4096
    s_add_u32 s3, s7, 0
    buffer_load_dwordx4 v112, s[12:15], s3 offen lds
    s_add_u32 m0, s28, 5120
    s_add_u32 s3, s7, 28672
    buffer_load_dwordx4 v112, s[12:15], s3 offen lds
    s_add_u32 m0, s28, 6144
    s_add_u32 s3, s7, 57344
    buffer_load_dwordx4 v112, s[12:15], s3 offen lds
    s_add_u32 m0, s28, 7168
    s_add_u32 s3, s7, 86016
    buffer_load_dwordx4 v112, s[12:15], s3 offen lds
Lact_fused_kernel_23:
    v_readfirstlane_b32 s35, v8
    s_nop 1
    v_subrev_f32 v28, s35, v8
    v_subrev_f32 v29, s35, v9
    v_subrev_f32 v30, s35, v10
    v_subrev_f32 v31, s35, v11
    v_subrev_f32 v32, s35, v12
    v_subrev_f32 v33, s35, v13
    v_subrev_f32 v34, s35, v14
    v_subrev_f32 v35, s35, v15
    v_add_f32 v24, v28, v29
    v_mul_f32 v25, v28, v28
    v_add_f32 v26, v30, v31
    v_mul_f32 v27, v29, v29
    v_add_f32 v24, v24, v32
    v_fmac_f32 v25, v30, v30
    v_add_f32 v26, v26, v33
    v_fmac_f32 v27, v31, v31
    v_add_f32 v24, v24, v34
    v_fmac_f32 v25, v32, v32
    v_add_f32 v26, v26, v35
    v_fmac_f32 v27, v33, v33
    v_fmac_f32 v25, v34, v34
    v_fmac_f32 v27, v35, v35
    v_add_f32 v24, v24, v26
    v_add_f32 v25, v25, v27
    s_nop 0
    v_add_f32_dpp v24, v24, v24 row_ror:8 row_mask:0xf bank_mask:0xf
    v_add_f32_dpp v25, v25, v25 row_ror:8 row_mask:0xf bank_mask:0xf
    s_nop 0
    v_add_f32_dpp v24, v24, v24 row_ror:4 row_mask:0xf bank_mask:0xf
    v_add_f32_dpp v25, v25, v25 row_ror:4 row_mask:0xf bank_mask:0xf
    s_nop 0
    v_add_f32_dpp v24, v24, v24 row_ror:2 row_mask:0xf bank_mask:0xf
    v_add_f32_dpp v25, v25, v25 row_ror:2 row_mask:0xf bank_mask:0xf
    s_nop 0
    v_add_f32_dpp v24, v24, v24 row_ror:1 row_mask:0xf bank_mask:0xf
    v_add_f32_dpp v25, v25, v25 row_ror:1 row_mask:0xf bank_mask:0xf
    s_nop 0
    v_add_f32_dpp v24, v24, v24 row_bcast:15 row_mask:0xa bank_mask:0xf
    v_add_f32_dpp v25, v25, v25 row_bcast:15 row_mask:0xa bank_mask:0xf
    s_nop 0
    v_add_f32_dpp v24, v24, v24 row_bcast:31 row_mask:0xc bank_mask:0xf
    v_add_f32_dpp v25, v25, v25 row_bcast:31 row_mask:0xc bank_mask:0xf
    v_readlane_b32 s33, v24, 63
    v_readlane_b32 s34, v25, 63
    s_nop 0
    v_mov_b32 v24, s33
    v_mov_b32 v25, s34
    v_mul_f32 v24, 0x3b000000, v24
    v_mul_f32 v25, 0x3b000000, v25
    v_fma_f32 v25, -v24, v24, v25
    v_add_f32 v24, s35, v24
    v_max_f32 v25, 0, v25
    v_cvt_pk_bf16_f32 v24, v24, v25
    v_and_b32 v25, 0xffff0000, v24
    v_lshlrev_b32 v24, 16, v24
    v_add_f32 v25, 0x3727c5ac, v25
    v_sub_f32 v28, v8, v24
    v_sub_f32 v29, v9, v24
    v_sub_f32 v30, v10, v24
    v_sub_f32 v31, v11, v24
    v_cvt_pk_bf16_f32 v25, v25, v25
    v_and_b32 v25, 0xffff0000, v25
    v_sub_f32 v32, v12, v24
    v_sub_f32 v33, v13, v24
    v_sub_f32 v34, v14, v24
    v_sub_f32 v35, v15, v24
    v_sqrt_f32 v25, v25
    v_cvt_pk_bf16_f32 v20, v28, v29
    v_cvt_pk_bf16_f32 v21, v30, v31
    v_cvt_pk_bf16_f32 v22, v32, v33
    v_cvt_pk_bf16_f32 v23, v34, v35
    v_cvt_pk_bf16_f32 v25, v25, v25
    v_and_b32 v25, 0xffff0000, v25
    v_lshlrev_b32 v28, 16, v20
    v_and_b32 v29, 0xffff0000, v20
    v_lshlrev_b32 v30, 16, v21
    v_and_b32 v31, 0xffff0000, v21
    v_rcp_f32 v25, v25
    v_lshlrev_b32 v32, 16, v22
    v_and_b32 v33, 0xffff0000, v22
    v_lshlrev_b32 v34, 16, v23
    v_and_b32 v35, 0xffff0000, v23
    v_mul_f32 v28, v28, v25
    v_mul_f32 v29, v29, v25
    v_mul_f32 v30, v30, v25
    v_mul_f32 v31, v31, v25
    v_mul_f32 v32, v32, v25
    v_mul_f32 v33, v33, v25
    v_mul_f32 v34, v34, v25
    v_mul_f32 v35, v35, v25
    v_cvt_pk_bf16_f32 v20, v28, v29
    v_cvt_pk_bf16_f32 v21, v30, v31
    v_cvt_pk_bf16_f32 v22, v32, v33
    v_cvt_pk_bf16_f32 v23, v34, v35
    s_cmp_eq_u32 s73, 7
    s_cbranch_scc1 Lact_fused_kernel_24
    s_add_u32 s7, s27, 688128
    s_add_u32 m0, s28, 8192
    s_add_u32 s3, s7, 0
    buffer_load_dwordx4 v112, s[12:15], s3 offen lds
    s_add_u32 m0, s28, 9216
    s_add_u32 s3, s7, 28672
    buffer_load_dwordx4 v112, s[12:15], s3 offen lds
    s_add_u32 m0, s28, 10240
    s_add_u32 s3, s7, 57344
    buffer_load_dwordx4 v112, s[12:15], s3 offen lds
    s_add_u32 m0, s28, 11264
    s_add_u32 s3, s7, 86016
    buffer_load_dwordx4 v112, s[12:15], s3 offen lds
    s_waitcnt vmcnt(12)
    ds_read_b64_tr_b16 v[176:177], v114 offset:12288
    ds_read_b64_tr_b16 v[178:179], v114 offset:12800
    ds_read_b64_tr_b16 v[180:181], v115 offset:12288
    ds_read_b64_tr_b16 v[182:183], v115 offset:12800
    ds_read_b64_tr_b16 v[184:185], v114 offset:14336
    ds_read_b64_tr_b16 v[186:187], v114 offset:14848
    ds_read_b64_tr_b16 v[188:189], v115 offset:14336
    ds_read_b64_tr_b16 v[190:191], v115 offset:14848
Lact_fused_kernel_24:
    v_lshlrev_b32 v8, 16, v20
    v_and_b32 v9, 0xffff0000, v20
    v_lshlrev_b32 v10, 16, v21
    v_and_b32 v11, 0xffff0000, v21
    v_lshlrev_b32 v12, 16, v22
    v_and_b32 v13, 0xffff0000, v22
    v_lshlrev_b32 v14, 16, v23
    v_and_b32 v15, 0xffff0000, v23
    v_add_f32 v24, v8, v9
    v_mul_f32 v25, v8, v8
    v_add_f32 v26, v10, v11
    v_mul_f32 v27, v9, v9
    v_add_f32 v24, v24, v12
    v_fmac_f32 v25, v10, v10
    v_add_f32 v26, v26, v13
    v_fmac_f32 v27, v11, v11
    v_add_f32 v24, v24, v14
    v_fmac_f32 v25, v12, v12
    v_add_f32 v26, v26, v15
    v_fmac_f32 v27, v13, v13
    v_fmac_f32 v25, v14, v14
    v_fmac_f32 v27, v15, v15
    v_add_f32 v24, v24, v26
    v_add_f32 v25, v25, v27
    s_nop 0
    v_add_f32_dpp v24, v24, v24 row_ror:8 row_mask:0xf bank_mask:0xf
    v_add_f32_dpp v25, v25, v25 row_ror:8 row_mask:0xf bank_mask:0xf
    s_nop 0
    v_add_f32_dpp v24, v24, v24 row_ror:4 row_mask:0xf bank_mask:0xf
    v_add_f32_dpp v25, v25, v25 row_ror:4 row_mask:0xf bank_mask:0xf
    s_nop 0
    v_add_f32_dpp v24, v24, v24 row_ror:2 row_mask:0xf bank_mask:0xf
    v_add_f32_dpp v25, v25, v25 row_ror:2 row_mask:0xf bank_mask:0xf
    s_nop 0
    v_add_f32_dpp v24, v24, v24 row_ror:1 row_mask:0xf bank_mask:0xf
    v_add_f32_dpp v25, v25, v25 row_ror:1 row_mask:0xf bank_mask:0xf
    s_nop 0
    v_add_f32_dpp v24, v24, v24 row_bcast:15 row_mask:0xa bank_mask:0xf
    v_add_f32_dpp v25, v25, v25 row_bcast:15 row_mask:0xa bank_mask:0xf
    s_nop 0
    v_add_f32_dpp v24, v24, v24 row_bcast:31 row_mask:0xc bank_mask:0xf
    v_add_f32_dpp v25, v25, v25 row_bcast:31 row_mask:0xc bank_mask:0xf
    v_readlane_b32 s33, v24, 63
    v_readlane_b32 s34, v25, 63
    s_nop 0
    v_mov_b32 v24, s33
    v_mov_b32 v25, s34
    v_mul_f32 v24, 0x3b000000, v24
    v_mul_f32 v25, 0x3b000000, v25
    v_fma_f32 v25, -v24, v24, v25
    v_max_f32 v25, 0, v25
    v_cvt_pk_bf16_f32 v24, v24, v25
    v_and_b32 v25, 0xffff0000, v24
    v_lshlrev_b32 v24, 16, v24
    v_add_f32 v25, 0x3727c5ac, v25
    v_sub_f32 v28, v8, v24
    v_sub_f32 v29, v9, v24
    v_sub_f32 v30, v10, v24
    v_sub_f32 v31, v11, v24
    v_cvt_pk_bf16_f32 v25, v25, v25
    v_and_b32 v25, 0xffff0000, v25
    v_sub_f32 v32, v12, v24
    v_sub_f32 v33, v13, v24
    v_sub_f32 v34, v14, v24
    v_sub_f32 v35, v15, v24
    v_sqrt_f32 v25, v25
    v_cvt_pk_bf16_f32 v20, v28, v29
    v_cvt_pk_bf16_f32 v21, v30, v31
    v_cvt_pk_bf16_f32 v22, v32, v33
    v_cvt_pk_bf16_f32 v23, v34, v35
    v_cvt_pk_bf16_f32 v25, v25, v25
    v_and_b32 v25, 0xffff0000, v25
    v_lshlrev_b32 v28, 16, v20
    v_and_b32 v29, 0xffff0000, v20
    v_lshlrev_b32 v30, 16, v21
    v_and_b32 v31, 0xffff0000, v21
    v_rcp_f32 v25, v25
    v_lshlrev_b32 v32, 16, v22
    v_and_b32 v33, 0xffff0000, v22
    v_lshlrev_b32 v34, 16, v23
    v_and_b32 v35, 0xffff0000, v23
    v_mul_f32 v28, v28, v25
    v_mul_f32 v29, v29, v25
    v_mul_f32 v30, v30, v25
    v_mul_f32 v31, v31, v25
    v_mul_f32 v32, v32, v25
    v_mul_f32 v33, v33, v25
    v_mul_f32 v34, v34, v25
    v_mul_f32 v35, v35, v25
    v_cvt_pk_bf16_f32 v20, v28, v29
    v_cvt_pk_bf16_f32 v21, v30, v31
    v_cvt_pk_bf16_f32 v22, v32, v33
    v_cvt_pk_bf16_f32 v23, v34, v35
    ds_write_b128 v100, v[20:23]
    s_waitcnt lgkmcnt(0)
    s_cmp_eq_u32 s73, 7
    s_cbranch_scc1 Lact_fused_kernel_25
    s_add_u32 s7, s27, 802816
    s_add_u32 m0, s28, 12288
    s_add_u32 s3, s7, 0
    buffer_load_dwordx4 v112, s[12:15], s3 offen lds
    s_add_u32 m0, s28, 13312
    s_add_u32 s3, s7, 28672
    buffer_load_dwordx4 v112, s[12:15], s3 offen lds
    s_add_u32 m0, s28, 14336
    s_add_u32 s3, s7, 57344
    buffer_load_dwordx4 v112, s[12:15], s3 offen lds
    s_add_u32 m0, s28, 15360
    s_add_u32 s3, s7, 86016
    buffer_load_dwordx4 v112, s[12:15], s3 offen lds
Lact_fused_kernel_25:
    s_cmp_lg_u32 s6, 0
    s_cbranch_scc1 Lpollx_fused_kernel_27
    v_lshlrev_b32 v38, 4, v1
    s_and_b32 s3, s5, 15
    s_lshl_b32 s3, s3, 10
    s_add_u32 s3, s3, 16842752
    s_mov_b32 s7, 0
Lpoll_fused_kernel_26:
    buffer_load_dwordx4 v[40:43], v38, s[8:11], s3 offen sc1
    s_add_u32 s7, s7, 1
    s_bitcmp1_b32 s7, 17
    s_cbranch_scc1 Lpollx_fused_kernel_27
    s_waitcnt vmcnt(0)
    v_xor_b32 v40, s20, v40
    v_xor_b32 v41, s20, v41
    v_xor_b32 v42, s20, v42
    v_xor_b32 v43, s20, v43
    v_or3_b32 v40, v40, v41, v42
    v_or_b32 v40, v40, v43
    v_cmp_ne_u32 vcc, 0, v40
    s_cbranch_vccnz Lpoll_fused_kernel_26
Lpollx_fused_kernel_27:
    s_waitcnt lgkmcnt(0)
    s_barrier
    ds_read_b64_tr_b16 v[40:41], v101
    ds_read_b64_tr_b16 v[42:43], v101 offset:4352
    s_lshl_b32 s29, s24, 13
    s_add_u32 s29, s29, 12582912
    v_lshlrev_b32 v3, 4, v0
    s_waitcnt lgkmcnt(0)
    v_min_u32 v40, s21, v40
    v_min_u32 v41, s21, v41
    v_min_u32 v42, s21, v42
    v_min_u32 v43, s21, v43
    buffer_store_dwordx4 v[40:43], v3, s[8:11], s29 offen sc1
    v_mov_b32 v44, v60
    v_mov_b32 v45, v61
    v_mov_b32 v48, v62
    v_mov_b32 v49, v63
    v_mov_b32 v46, s20
    v_mov_b32 v47, s22
    v_mov_b32 v50, s20
    v_mov_b32 v51, s22
    v_lshlrev_b32 v43, 4, v1
    s_lshl_b32 s3, s26, 1
    s_add_u32 s3, s3, 8388608
    buffer_store_dwordx4 v[44:47], v43, s[8:11], s3 offen sc1
    buffer_store_dwordx4 v[48:51], v43, s[8:11], s3 offen offset:1024 sc1
    s_cmp_eq_u32 s73, 7
    s_cbranch_scc1 Lskip1_fused_kernel_16
    v_lshrrev_b32 v3, 5, v1
    v_lshlrev_b32 v3, 13, v3
    v_and_b32 v4, 31, v1
    v_lshl_add_u32 v3, v4, 4, v3
    s_mul_i32 s29, s6, 262144
    s_lshl_b32 s30, s70, 10
    s_add_u32 s29, s29, s30
    s_add_u32 s29, s29, 12582912
    v_lshrrev_b32 v4, 5, v1
    v_lshlrev_b32 v4, 9, v4
    v_and_b32 v5, 31, v1
    v_lshl_add_u32 v4, v5, 4, v4
    s_lshl_b32 s31, s6, 13
    v_add_u32 v4, s31, v4
    v_lshrrev_b32 v5, 5, v1
    v_lshlrev_b32 v5, 9, v5
    v_and_b32 v6, 31, v1
    v_lshl_add_u32 v5, v6, 4, v5
    s_lshl_b32 s31, s6, 10
    v_add_u32 v5, s31, v5
    v_lshrrev_b32 v6, 5, v1
    v_lshlrev_b32 v6, 3, v6
    s_lshl_b32 s30, s71, 7
    s_lshl_b32 s31, s6, 4
    s_add_u32 s30, s30, s31
    v_add_u32 v6, s30, v6
    global_load_dwordx2 v[12:13], v6, s[58:59]
    v_and_b32 v6, 31, v1
    v_lshlrev_b32 v6, 4, v6
    v_lshrrev_b32 v7, 5, v1
    v_lshl_add_u32 v6, v7, 3, v6
    s_lshl_b32 s30, s71, 3
    s_add_u32 s30, s30, s6
    s_lshl_b32 s30, s30, 13
    s_lshl_b32 s31, s70, 10
    s_add_u32 s30, s30, s31
    s_add_u32 s30, s30, 14680064
    s_waitcnt vmcnt(8)
    ds_read_b64_tr_b16 v[192:193], v114 offset:0
    ds_read_b64_tr_b16 v[194:195], v114 offset:512
    ds_read_b64_tr_b16 v[196:197], v115 offset:0
    ds_read_b64_tr_b16 v[198:199], v115 offset:512
    ds_read_b64_tr_b16 v[200:201], v114 offset:2048
    ds_read_b64_tr_b16 v[202:203], v114 offset:2560
    ds_read_b64_tr_b16 v[204:205], v115 offset:2048
    ds_read_b64_tr_b16 v[206:207], v115 offset:2560
    ds_read_b64_tr_b16 v[208:209], v114 offset:4096
    ds_read_b64_tr_b16 v[210:211], v114 offset:4608
    ds_read_b64_tr_b16 v[212:213], v115 offset:4096
    ds_read_b64_tr_b16 v[214:215], v115 offset:4608
    ds_read_b64_tr_b16 v[216:217], v114 offset:6144
    ds_read_b64_tr_b16 v[218:219], v114 offset:6656
    ds_read_b64_tr_b16 v[220:221], v115 offset:6144
    ds_read_b64_tr_b16 v[222:223], v115 offset:6656
    ds_read_b64_tr_b16 v[224:225], v114 offset:8192
    ds_read_b64_tr_b16 v[226:227], v114 offset:8704
    ds_read_b64_tr_b16 v[228:229], v115 offset:8192
    ds_read_b64_tr_b16 v[230:231], v115 offset:8704
    ds_read_b64_tr_b16 v[232:233], v114 offset:10240
    ds_read_b64_tr_b16 v[234:235], v114 offset:10752
    ds_read_b64_tr_b16 v[236:237], v115 offset:10240
    ds_read_b64_tr_b16 v[238:239], v115 offset:10752
    s_waitcnt vmcnt(4)
    ds_read_b64_tr_b16 v[240:241], v114 offset:12288
    ds_read_b64_tr_b16 v[242:243], v114 offset:12800
    ds_read_b64_tr_b16 v[244:245], v115 offset:12288
    ds_read_b64_tr_b16 v[246:247], v115 offset:12800
    ds_read_b64_tr_b16 v[248:249], v114 offset:14336
    ds_read_b64_tr_b16 v[250:251], v114 offset:14848
    ds_read_b64_tr_b16 v[252:253], v115 offset:14336
    ds_read_b64_tr_b16 v[254:255], v115 offset:14848
    s_waitcnt lgkmcnt(0)
    s_barrier
    s_mov_b32 s12, s60
    s_mov_b32 s13, s61
    s_mov_b32 s14, 7340032
    s_mov_b32 s15, 0x20000
    v_lshrrev_b32 v16, 3, v1
    v_and_b32 v17, 7, v1
    v_bfe_u32 v18, v16, 1, 1
    v_lshlrev_b32 v18, 2, v18
    v_xor_b32 v17, v17, v18
    v_mul_u32_u24 v16, 4096, v16
    v_lshl_add_u32 v60, v17, 4, v16
    s_mul_i32 s27, s6, 917504
    s_lshl_b32 s3, s72, 7
    s_add_u32 s27, s27, s3
    v_lshrrev_b32 v17, 4, v1
    v_bfe_u32 v18, v1, 2, 2
    v_and_b32 v19, 3, v1
    v_lshrrev_b32 v20, 1, v17
    v_lshl_add_u32 v20, v20, 3, v18
    v_lshlrev_b32 v20, 7, v20
    v_and_b32 v21, 1, v17
    v_lshlrev_b32 v21, 1, v21
    v_lshrrev_b32 v22, 1, v19
    v_add_u32 v21, v21, v22
    v_bfe_u32 v22, v18, 1, 1
    v_lshl_add_u32 v21, v22, 2, v21
    v_lshl_add_u32 v20, v21, 4, v20
    v_and_b32 v22, 1, v19
    v_lshl_add_u32 v61, v22, 3, v20
    s_mul_i32 s28, s6, 12288
    s_add_u32 s28, s28, 65536
    v_add_u32 v62, s28, v61
    v_xor_b32 v63, 64, v62
    s_add_u32 s7, s27, 0
    s_add_u32 m0, s28, 0
    s_add_u32 s3, s7, 0
    buffer_load_dwordx4 v60, s[12:15], s3 offen lds
    s_add_u32 m0, s28, 1024
    s_add_u32 s3, s7, 32768
    buffer_load_dwordx4 v60, s[12:15], s3 offen lds
    s_add_u32 m0, s28, 2048
    s_add_u32 s3, s7, 65536
    buffer_load_dwordx4 v60, s[12:15], s3 offen lds
    s_add_u32 m0, s28, 3072
    s_add_u32 s3, s7, 98304
    buffer_load_dwordx4 v60, s[12:15], s3 offen lds
    s_add_u32 s7, s27, 131072
    s_add_u32 m0, s28, 4096
    s_add_u32 s3, s7, 0
    buffer_load_dwordx4 v60, s[12:15], s3 offen lds
    s_add_u32 m0, s28, 5120
    s_add_u32 s3, s7, 32768
    buffer_load_dwordx4 v60, s[12:15], s3 offen lds
    s_add_u32 m0, s28, 6144
    s_add_u32 s3, s7, 65536
    buffer_load_dwordx4 v60, s[12:15], s3 offen lds
    s_add_u32 m0, s28, 7168
    s_add_u32 s3, s7, 98304
    buffer_load_dwordx4 v60, s[12:15], s3 offen lds
    s_add_u32 s7, s27, 262144
    s_add_u32 m0, s28, 8192
    s_add_u32 s3, s7, 0
    buffer_load_dwordx4 v60, s[12:15], s3 offen lds
    s_add_u32 m0, s28, 9216
    s_add_u32 s3, s7, 32768
    buffer_load_dwordx4 v60, s[12:15], s3 offen lds
    s_add_u32 m0, s28, 10240
    s_add_u32 s3, s7, 65536
    buffer_load_dwordx4 v60, s[12:15], s3 offen lds
    s_add_u32 m0, s28, 11264
    s_add_u32 s3, s7, 98304
    buffer_load_dwordx4 v60, s[12:15], s3 offen lds
    s_add_u32 s31, s29, 0
    s_mov_b32 s7, 0
Lval_fused_kernel_28:
    buffer_load_dwordx4 v[16:19], v3, s[8:11], s31 offen sc1
    s_add_u32 s7, s7, 1
    s_bitcmp1_b32 s7, 17
    s_cbranch_scc1 Lvalx_fused_kernel_29
    s_waitcnt vmcnt(0)
    s_mov_b64 exec, -1
    v_max3_u32 v2, v16, v17, v18
    v_max_u32 v2, v2, v19
    v_cmp_eq_u32 vcc, -1, v2
    s_mov_b64 exec, vcc
    s_cbranch_vccnz Lval_fused_kernel_28
Lvalx_fused_kernel_29:
    s_mov_b64 exec, -1
    s_waitcnt vmcnt(0)
    s_add_u32 s31, s29, 16384
    buffer_load_dwordx4 v[20:23], v3, s[8:11], s31 offen sc1
    s_add_u32 s31, s29, 32768
    buffer_load_dwordx4 v[24:27], v3, s[8:11], s31 offen sc1
    s_add_u32 s31, s29, 49152
    buffer_load_dwordx4 v[28:31], v3, s[8:11], s31 offen sc1
    s_add_u32 s31, s29, 65536
    buffer_load_dwordx4 v[32:35], v3, s[8:11], s31 offen sc1
    v_mfma_f32_32x32x16_bf16 v[64:79], v[128:131], v[16:19], 0
    v_mfma_f32_32x32x16_bf16 v[80:95], v[132:135], v[16:19], 0
    s_add_u32 s31, s29, 81920
    buffer_load_dwordx4 v[16:19], v3, s[8:11], s31 offen sc1
    s_waitcnt vmcnt(4)
Lchk_fused_kernel_30:
    v_max3_u32 v2, v20, v21, v22
    v_max_u32 v2, v2, v23
    v_cmp_eq_u32 vcc, -1, v2
    s_cbranch_vccnz Lstub_fused_kernel_31
    v_mfma_f32_32x32x16_bf16 v[64:79], v[136:139], v[20:23], v[64:79]
    v_mfma_f32_32x32x16_bf16 v[80:95], v[140:143], v[20:23], v[80:95]
    s_add_u32 s31, s29, 98304
    buffer_load_dwordx4 v[20:23], v3, s[8:11], s31 offen sc1
    s_waitcnt vmcnt(4)
Lchk_fused_kernel_32:
    v_max3_u32 v2, v24, v25, v26
    v_max_u32 v2, v2, v27
    v_cmp_eq_u32 vcc, -1, v2
    s_cbranch_vccnz Lstub_fused_kernel_33
    v_mfma_f32_32x32x16_bf16 v[64:79], v[144:147], v[24:27], v[64:79]
    v_mfma_f32_32x32x16_bf16 v[80:95], v[148:151], v[24:27], v[80:95]
    s_add_u32 s31, s29, 114688
    buffer_load_dwordx4 v[24:27], v3, s[8:11], s31 offen sc1
    s_waitcnt vmcnt(4)
Lchk_fused_kernel_34:
    v_max3_u32 v2, v28, v29, v30
    v_max_u32 v2, v2, v31
    v_cmp_eq_u32 vcc, -1, v2
    s_cbranch_vccnz Lstub_fused_kernel_35
    v_mfma_f32_32x32x16_bf16 v[64:79], v[152:155], v[28:31], v[64:79]
    v_mfma_f32_32x32x16_bf16 v[80:95], v[156:159], v[28:31], v[80:95]
    s_add_u32 s31, s29, 131072
    buffer_load_dwordx4 v[28:31], v3, s[8:11], s31 offen sc1
    s_waitcnt vmcnt(4)
Lchk_fused_kernel_36:
    v_max3_u32 v2, v32, v33, v34
    v_max_u32 v2, v2, v35
    v_cmp_eq_u32 vcc, -1, v2
    s_cbranch_vccnz Lstub_fused_kernel_37
    v_mfma_f32_32x32x16_bf16 v[64:79], v[160:163], v[32:35], v[64:79]
    v_mfma_f32_32x32x16_bf16 v[80:95], v[164:167], v[32:35], v[80:95]
    s_add_u32 s31, s29, 147456
    buffer_load_dwordx4 v[32:35], v3, s[8:11], s31 offen sc1
    s_waitcnt vmcnt(4)
Lchk_fused_kernel_38:
    v_max3_u32 v2, v16, v17, v18
    v_max_u32 v2, v2, v19
    v_cmp_eq_u32 vcc, -1, v2
    s_cbranch_vccnz Lstub_fused_kernel_39
    v_mfma_f32_32x32x16_bf16 v[64:79], v[168:171], v[16:19], v[64:79]
    v_mfma_f32_32x32x16_bf16 v[80:95], v[172:175], v[16:19], v[80:95]
    s_add_u32 s31, s29, 163840
    buffer_load_dwordx4 v[16:19], v3, s[8:11], s31 offen sc1
    s_waitcnt vmcnt(4)
Lchk_fused_kernel_40:
    v_max3_u32 v2, v20, v21, v22
    v_max_u32 v2, v2, v23
    v_cmp_eq_u32 vcc, -1, v2
    s_cbranch_vccnz Lstub_fused_kernel_41
    v_mfma_f32_32x32x16_bf16 v[64:79], v[176:179], v[20:23], v[64:79]
    v_mfma_f32_32x32x16_bf16 v[80:95], v[180:183], v[20:23], v[80:95]
    s_add_u32 s31, s29, 180224
    buffer_load_dwordx4 v[20:23], v3, s[8:11], s31 offen sc1
    s_waitcnt vmcnt(4)
Lchk_fused_kernel_42:
    v_max3_u32 v2, v24, v25, v26
    v_max_u32 v2, v2, v27
    v_cmp_eq_u32 vcc, -1, v2
    s_cbranch_vccnz Lstub_fused_kernel_43
    v_mfma_f32_32x32x16_bf16 v[64:79], v[184:187], v[24:27], v[64:79]
    v_mfma_f32_32x32x16_bf16 v[80:95], v[188:191], v[24:27], v[80:95]
    s_add_u32 s31, s29, 196608
    buffer_load_dwordx4 v[24:27], v3, s[8:11], s31 offen sc1
    s_waitcnt vmcnt(4)
Lchk_fused_kernel_44:
    v_max3_u32 v2, v28, v29, v30
    v_max_u32 v2, v2, v31
    v_cmp_eq_u32 vcc, -1, v2
    s_cbranch_vccnz Lstub_fused_kernel_45
    v_mfma_f32_32x32x16_bf16 v[64:79], v[192:195], v[28:31], v[64:79]
    v_mfma_f32_32x32x16_bf16 v[80:95], v[196:199], v[28:31], v[80:95]
    s_add_u32 s31, s29, 212992
    buffer_load_dwordx4 v[28:31], v3, s[8:11], s31 offen sc1
    s_waitcnt vmcnt(4)
Lchk_fused_kernel_46:
    v_max3_u32 v2, v32, v33, v34
    v_max_u32 v2, v2, v35
    v_cmp_eq_u32 vcc, -1, v2
    s_cbranch_vccnz Lstub_fused_kernel_47
    v_mfma_f32_32x32x16_bf16 v[64:79], v[200:203], v[32:35], v[64:79]
    v_mfma_f32_32x32x16_bf16 v[80:95], v[204:207], v[32:35], v[80:95]
    s_add_u32 s31, s29, 229376
    buffer_load_dwordx4 v[32:35], v3, s[8:11], s31 offen sc1
    s_waitcnt vmcnt(4)
Lchk_fused_kernel_48:
    v_max3_u32 v2, v16, v17, v18
    v_max_u32 v2, v2, v19
    v_cmp_eq_u32 vcc, -1, v2
    s_cbranch_vccnz Lstub_fused_kernel_49
    v_mfma_f32_32x32x16_bf16 v[64:79], v[208:211], v[16:19], v[64:79]
    v_mfma_f32_32x32x16_bf16 v[80:95], v[212:215], v[16:19], v[80:95]
    s_add_u32 s31, s29, 245760
    buffer_load_dwordx4 v[16:19], v3, s[8:11], s31 offen sc1
    s_waitcnt vmcnt(4)
Lchk_fused_kernel_50:
    v_max3_u32 v2, v20, v21, v22
    v_max_u32 v2, v2, v23
    v_cmp_eq_u32 vcc, -1, v2
    s_cbranch_vccnz Lstub_fused_kernel_51
    v_mfma_f32_32x32x16_bf16 v[64:79], v[216:219], v[20:23], v[64:79]
    v_mfma_f32_32x32x16_bf16 v[80:95], v[220:223], v[20:23], v[80:95]
    s_add_u32 s31, s29, 512
    buffer_load_dwordx4 v[20:23], v3, s[8:11], s31 offen sc1
    s_waitcnt vmcnt(4)
Lchk_fused_kernel_52:
    v_max3_u32 v2, v24, v25, v26
    v_max_u32 v2, v2, v27
    v_cmp_eq_u32 vcc, -1, v2
    s_cbranch_vccnz Lstub_fused_kernel_53
    v_mfma_f32_32x32x16_bf16 v[64:79], v[224:227], v[24:27], v[64:79]
    v_mfma_f32_32x32x16_bf16 v[80:95], v[228:231], v[24:27], v[80:95]
    s_add_u32 s31, s29, 16896
    buffer_load_dwordx4 v[24:27], v3, s[8:11], s31 offen sc1
    s_waitcnt vmcnt(4)
Lchk_fused_kernel_54:
    v_max3_u32 v2, v28, v29, v30
    v_max_u32 v2, v2, v31
    v_cmp_eq_u32 vcc, -1, v2
    s_cbranch_vccnz Lstub_fused_kernel_55
    v_mfma_f32_32x32x16_bf16 v[64:79], v[232:235], v[28:31], v[64:79]
    v_mfma_f32_32x32x16_bf16 v[80:95], v[236:239], v[28:31], v[80:95]
    s_add_u32 s31, s29, 33280
    buffer_load_dwordx4 v[28:31], v3, s[8:11], s31 offen sc1
    s_waitcnt vmcnt(4)
Lchk_fused_kernel_56:
    v_max3_u32 v2, v32, v33, v34
    v_max_u32 v2, v2, v35
    v_cmp_eq_u32 vcc, -1, v2
    s_cbranch_vccnz Lstub_fused_kernel_57
    v_mfma_f32_32x32x16_bf16 v[64:79], v[240:243], v[32:35], v[64:79]
    v_mfma_f32_32x32x16_bf16 v[80:95], v[244:247], v[32:35], v[80:95]
    s_add_u32 s31, s29, 49664
    buffer_load_dwordx4 v[32:35], v3, s[8:11], s31 offen sc1
    s_waitcnt vmcnt(4)
Lchk_fused_kernel_58:
    v_max3_u32 v2, v16, v17, v18
    v_max_u32 v2, v2, v19
    v_cmp_eq_u32 vcc, -1, v2
    s_cbranch_vccnz Lstub_fused_kernel_59
    v_mfma_f32_32x32x16_bf16 v[64:79], v[248:251], v[16:19], v[64:79]
    v_mfma_f32_32x32x16_bf16 v[80:95], v[252:255], v[16:19], v[80:95]
    s_add_u32 s31, s29, 66048
    buffer_load_dwordx4 v[16:19], v3, s[8:11], s31 offen sc1
    s_waitcnt vmcnt(4)
Lchk_fused_kernel_60:
    v_max3_u32 v2, v20, v21, v22
    v_max_u32 v2, v2, v23
    v_cmp_eq_u32 vcc, -1, v2
    s_cbranch_vccnz Lstub_fused_kernel_61
    v_mfma_f32_32x32x16_bf16 v[96:111], v[128:131], v[20:23], 0
    v_mfma_f32_32x32x16_bf16 v[112:127], v[132:135], v[20:23], 0
    s_add_u32 s31, s29, 82432
    buffer_load_dwordx4 v[20:23], v3, s[8:11], s31 offen sc1
    s_waitcnt vmcnt(4)
Lchk_fused_kernel_62:
    v_max3_u32 v2, v24, v25, v26
    v_max_u32 v2, v2, v27
    v_cmp_eq_u32 vcc, -1, v2
    s_cbranch_vccnz Lstub_fused_kernel_63
    v_mfma_f32_32x32x16_bf16 v[96:111], v[136:139], v[24:27], v[96:111]
    v_mfma_f32_32x32x16_bf16 v[112:127], v[140:143], v[24:27], v[112:127]
    s_add_u32 s31, s29, 98816
    buffer_load_dwordx4 v[24:27], v3, s[8:11], s31 offen sc1
    ds_write_b128 v4, v[64:67] offset:0
    ds_write_b128 v4, v[68:71] offset:1024
    s_waitcnt vmcnt(4)
Lchk_fused_kernel_64:
    v_max3_u32 v2, v28, v29, v30
    v_max_u32 v2, v2, v31
    v_cmp_eq_u32 vcc, -1, v2
    s_cbranch_vccnz Lstub_fused_kernel_65
    v_mfma_f32_32x32x16_bf16 v[96:111], v[144:147], v[28:31], v[96:111]
    v_mfma_f32_32x32x16_bf16 v[112:127], v[148:151], v[28:31], v[112:127]
    s_add_u32 s31, s29, 115200
    buffer_load_dwordx4 v[28:31], v3, s[8:11], s31 offen sc1
    ds_write_b128 v4, v[72:75] offset:2048
    ds_write_b128 v4, v[76:79] offset:3072
    s_waitcnt vmcnt(4)
Lchk_fused_kernel_66:
    v_max3_u32 v2, v32, v33, v34
    v_max_u32 v2, v2, v35
    v_cmp_eq_u32 vcc, -1, v2
    s_cbranch_vccnz Lstub_fused_kernel_67
    v_mfma_f32_32x32x16_bf16 v[96:111], v[152:155], v[32:35], v[96:111]
    v_mfma_f32_32x32x16_bf16 v[112:127], v[156:159], v[32:35], v[112:127]
    s_add_u32 s31, s29, 131584
    buffer_load_dwordx4 v[32:35], v3, s[8:11], s31 offen sc1
    ds_write_b128 v4, v[80:83] offset:4096
    ds_write_b128 v4, v[84:87] offset:5120
    s_waitcnt vmcnt(4)
Lchk_fused_kernel_68:
    v_max3_u32 v2, v16, v17, v18
    v_max_u32 v2, v2, v19
    v_cmp_eq_u32 vcc, -1, v2
    s_cbranch_vccnz Lstub_fused_kernel_69
    v_mfma_f32_32x32x16_bf16 v[96:111], v[160:163], v[16:19], v[96:111]
    v_mfma_f32_32x32x16_bf16 v[112:127], v[164:167], v[16:19], v[112:127]
    s_add_u32 s31, s29, 147968
    buffer_load_dwordx4 v[16:19], v3, s[8:11], s31 offen sc1
    ds_write_b128 v4, v[88:91] offset:6144
    ds_write_b128 v4, v[92:95] offset:7168
    s_waitcnt vmcnt(4)
Lchk_fused_kernel_70:
    v_max3_u32 v2, v20, v21, v22
    v_max_u32 v2, v2, v23
    v_cmp_eq_u32 vcc, -1, v2
    s_cbranch_vccnz Lstub_fused_kernel_71
    v_mfma_f32_32x32x16_bf16 v[96:111], v[168:171], v[20:23], v[96:111]
    v_mfma_f32_32x32x16_bf16 v[112:127], v[172:175], v[20:23], v[112:127]
    s_add_u32 s31, s29, 164352
    buffer_load_dwordx4 v[20:23], v3, s[8:11], s31 offen sc1
    s_waitcnt vmcnt(4)
Lchk_fused_kernel_72:
    v_max3_u32 v2, v24, v25, v26
    v_max_u32 v2, v2, v27
    v_cmp_eq_u32 vcc, -1, v2
    s_cbranch_vccnz Lstub_fused_kernel_73
    v_mfma_f32_32x32x16_bf16 v[96:111], v[176:179], v[24:27], v[96:111]
    v_mfma_f32_32x32x16_bf16 v[112:127], v[180:183], v[24:27], v[112:127]
    s_add_u32 s31, s29, 180736
    buffer_load_dwordx4 v[24:27], v3, s[8:11], s31 offen sc1
    s_waitcnt lgkmcnt(0)
    s_barrier
    v_add_u32 v7, 32768, v5
    ds_read_b128 v[64:67], v5 offset:0
    ds_read_b128 v[68:71], v5 offset:8192
    ds_read_b128 v[72:75], v5 offset:16384
    ds_read_b128 v[76:79], v5 offset:24576
    ds_read_b128 v[80:83], v7 offset:0
    ds_read_b128 v[84:87], v7 offset:8192
    ds_read_b128 v[88:91], v7 offset:16384
    ds_read_b128 v[92:95], v7 offset:24576
    s_waitcnt vmcnt(4)
Lchk_fused_kernel_74:
    v_max3_u32 v2, v28, v29, v30
    v_max_u32 v2, v2, v31
    v_cmp_eq_u32 vcc, -1, v2
    s_cbranch_vccnz Lstub_fused_kernel_75
    v_mfma_f32_32x32x16_bf16 v[96:111], v[184:187], v[28:31], v[96:111]
    v_mfma_f32_32x32x16_bf16 v[112:127], v[188:191], v[28:31], v[112:127]
    s_add_u32 s31, s29, 197120
    buffer_load_dwordx4 v[28:31], v3, s[8:11], s31 offen sc1
    s_waitcnt vmcnt(4)
Lchk_fused_kernel_76:
    v_max3_u32 v2, v32, v33, v34
    v_max_u32 v2, v2, v35
    v_cmp_eq_u32 vcc, -1, v2
    s_cbranch_vccnz Lstub_fused_kernel_77
    v_mfma_f32_32x32x16_bf16 v[96:111], v[192:195], v[32:35], v[96:111]
    v_mfma_f32_32x32x16_bf16 v[112:127], v[196:199], v[32:35], v[112:127]
    s_add_u32 s31, s29, 213504
    buffer_load_dwordx4 v[32:35], v3, s[8:11], s31 offen sc1
    s_waitcnt lgkmcnt(0)
    v_add_f32 v64, v64, v80
    v_add_f32 v65, v65, v81
    v_add_f32 v66, v66, v82
    v_add_f32 v67, v67, v83
    v_add_f32 v68, v68, v84
    v_add_f32 v69, v69, v85
    v_add_f32 v70, v70, v86
    v_add_f32 v71, v71, v87
    v_add_f32 v72, v72, v88
    v_add_f32 v73, v73, v89
    s_waitcnt vmcnt(4)
Lchk_fused_kernel_78:
    v_max3_u32 v2, v16, v17, v18
    v_max_u32 v2, v2, v19
    v_cmp_eq_u32 vcc, -1, v2
    s_cbranch_vccnz Lstub_fused_kernel_79
    v_mfma_f32_32x32x16_bf16 v[96:111], v[200:203], v[16:19], v[96:111]
    v_mfma_f32_32x32x16_bf16 v[112:127], v[204:207], v[16:19], v[112:127]
    s_add_u32 s31, s29, 229888
    buffer_load_dwordx4 v[16:19], v3, s[8:11], s31 offen sc1
    v_add_f32 v74, v74, v90
    v_add_f32 v75, v75, v91
    v_add_f32 v76, v76, v92
    v_add_f32 v77, v77, v93
    v_add_f32 v78, v78, v94
    v_add_f32 v79, v79, v95
    v_add_f32 v64, v64, v72
    v_add_f32 v65, v65, v73
    v_add_f32 v66, v66, v74
    v_add_f32 v67, v67, v75
    s_waitcnt vmcnt(4)
Lchk_fused_kernel_80:
    v_max3_u32 v2, v20, v21, v22
    v_max_u32 v2, v2, v23
    v_cmp_eq_u32 vcc, -1, v2
    s_cbranch_vccnz Lstub_fused_kernel_81
    v_mfma_f32_32x32x16_bf16 v[96:111], v[208:211], v[20:23], v[96:111]
    v_mfma_f32_32x32x16_bf16 v[112:127], v[212:215], v[20:23], v[112:127]
    s_add_u32 s31, s29, 246272
    buffer_load_dwordx4 v[20:23], v3, s[8:11], s31 offen sc1
    ds_read_b64_tr_b16 v[128:129], v62 offset:0
    ds_read_b64_tr_b16 v[130:131], v62 offset:512
    ds_read_b64_tr_b16 v[132:133], v63 offset:0
    ds_read_b64_tr_b16 v[134:135], v63 offset:512
    ds_read_b64_tr_b16 v[136:137], v62 offset:2048
    ds_read_b64_tr_b16 v[138:139], v62 offset:2560
    ds_read_b64_tr_b16 v[140:141], v63 offset:2048
    ds_read_b64_tr_b16 v[142:143], v63 offset:2560
    v_add_f32 v68, v68, v76
    v_add_f32 v69, v69, v77
    v_add_f32 v70, v70, v78
    v_add_f32 v71, v71, v79
    v_add_f32 v64, v64, v68
    v_add_f32 v65, v65, v69
    v_add_f32 v66, v66, v70
    v_add_f32 v67, v67, v71
    v_cvt_pk_bf16_f32 v68, v64, v65
    v_cvt_pk_bf16_f32 v69, v66, v67
    s_waitcnt vmcnt(4)
Lchk_fused_kernel_82:
    v_max3_u32 v2, v24, v25, v26
    v_max_u32 v2, v2, v27
    v_cmp_eq_u32 vcc, -1, v2
    s_cbranch_vccnz Lstub_fused_kernel_83
    v_mfma_f32_32x32x16_bf16 v[96:111], v[216:219], v[24:27], v[96:111]
    v_mfma_f32_32x32x16_bf16 v[112:127], v[220:223], v[24:27], v[112:127]
    ds_read_b64_tr_b16 v[144:145], v62 offset:4096
    ds_read_b64_tr_b16 v[146:147], v62 offset:4608
    ds_read_b64_tr_b16 v[148:149], v63 offset:4096
    ds_read_b64_tr_b16 v[150:151], v63 offset:4608
    ds_read_b64_tr_b16 v[152:153], v62 offset:6144
    ds_read_b64_tr_b16 v[154:155], v62 offset:6656
    ds_read_b64_tr_b16 v[156:157], v63 offset:6144
    ds_read_b64_tr_b16 v[158:159], v63 offset:6656
    v_lshlrev_b32 v64, 16, v68
    v_and_b32 v65, 0xffff0000, v68
    v_lshlrev_b32 v66, 16, v69
    v_and_b32 v67, 0xffff0000, v69
    v_lshlrev_b32 v70, 16, v12
    v_and_b32 v71, 0xffff0000, v12
    v_lshlrev_b32 v72, 16, v13
    v_and_b32 v73, 0xffff0000, v13
    v_add_f32 v64, v64, v70
    v_add_f32 v65, v65, v71
    v_add_f32 v66, v66, v72
    s_waitcnt vmcnt(3)
Lchk_fused_kernel_84:
    v_max3_u32 v2, v28, v29, v30
    v_max_u32 v2, v2, v31
    v_cmp_eq_u32 vcc, -1, v2
    s_cbranch_vccnz Lstub_fused_kernel_85
    v_mfma_f32_32x32x16_bf16 v[96:111], v[224:227], v[28:31], v[96:111]
    v_mfma_f32_32x32x16_bf16 v[112:127], v[228:231], v[28:31], v[112:127]
    ds_read_b64_tr_b16 v[160:161], v62 offset:8192
    ds_read_b64_tr_b16 v[162:163], v62 offset:8704
    ds_read_b64_tr_b16 v[164:165], v63 offset:8192
    ds_read_b64_tr_b16 v[166:167], v63 offset:8704
    ds_read_b64_tr_b16 v[168:169], v62 offset:10240
    ds_read_b64_tr_b16 v[170:171], v62 offset:10752
    ds_read_b64_tr_b16 v[172:173], v63 offset:10240
    ds_read_b64_tr_b16 v[174:175], v63 offset:10752
    v_add_f32 v67, v67, v73
    v_cvt_pk_bf16_f32 v68, v64, v65
    v_cvt_pk_bf16_f32 v69, v66, v67
    v_lshlrev_b32 v64, 16, v68
    v_and_b32 v65, 0xffff0000, v68
    v_lshlrev_b32 v66, 16, v69
    v_and_b32 v67, 0xffff0000, v69
    s_mov_b32 s32, 0xbdd2d3e8
    v_mov_b32 v74, 0xc0135761
    v_mul_f32 v76, v64, v64
    s_waitcnt vmcnt(2)
Lchk_fused_kernel_86:
    v_max3_u32 v2, v32, v33, v34
    v_max_u32 v2, v2, v35
    v_cmp_eq_u32 vcc, -1, v2
    s_cbranch_vccnz Lstub_fused_kernel_87
    v_mfma_f32_32x32x16_bf16 v[96:111], v[232:235], v[32:35], v[96:111]
    v_mfma_f32_32x32x16_bf16 v[112:127], v[236:239], v[32:35], v[112:127]
    v_mul_f32 v77, v65, v65
    v_mul_f32 v78, v66, v66
    v_mul_f32 v79, v67, v67
    v_fma_f32 v76, v76, s32, v74
    v_fma_f32 v77, v77, s32, v74
    v_fma_f32 v78, v78, s32, v74
    v_fma_f32 v79, v79, s32, v74
    v_mul_f32 v76, v76, v64
    v_mul_f32 v77, v77, v65
    v_mul_f32 v78, v78, v66
    s_waitcnt vmcnt(1)
Lchk_fused_kernel_88:
    v_max3_u32 v2, v16, v17, v18
    v_max_u32 v2, v2, v19
    v_cmp_eq_u32 vcc, -1, v2
    s_cbranch_vccnz Lstub_fused_kernel_89
    v_mfma_f32_32x32x16_bf16 v[96:111], v[240:243], v[16:19], v[96:111]
    v_mfma_f32_32x32x16_bf16 v[112:127], v[244:247], v[16:19], v[112:127]
    v_mul_f32 v79, v79, v67
    v_exp_f32 v76, v76
    v_exp_f32 v77, v77
    v_exp_f32 v78, v78
    v_exp_f32 v79, v79
    v_add_f32 v76, 1.0, v76
    v_add_f32 v77, 1.0, v77
    v_add_f32 v78, 1.0, v78
    v_add_f32 v79, 1.0, v79
    v_rcp_f32 v76, v76
    s_waitcnt vmcnt(0)
Lchk_fused_kernel_90:
    v_max3_u32 v2, v20, v21, v22
    v_max_u32 v2, v2, v23
    v_cmp_eq_u32 vcc, -1, v2
    s_cbranch_vccnz Lstub_fused_kernel_91
    v_mfma_f32_32x32x16_bf16 v[96:111], v[248:251], v[20:23], v[96:111]
    v_mfma_f32_32x32x16_bf16 v[112:127], v[252:255], v[20:23], v[112:127]
    v_rcp_f32 v77, v77
    v_rcp_f32 v78, v78
    v_rcp_f32 v79, v79
    v_mul_f32 v76, v76, v64
    v_mul_f32 v77, v77, v65
    v_mul_f32 v78, v78, v66
    v_mul_f32 v79, v79, v67
    v_cvt_pk_bf16_f32 v68, v76, v77
    v_cvt_pk_bf16_f32 v69, v78, v79
    v_min_u32 v8, s21, v68
    v_min_u32 v9, s21, v69
    s_barrier
    ds_write_b128 v4, v[96:99] offset:0
    ds_write_b128 v4, v[100:103] offset:1024
    ds_write_b128 v4, v[104:107] offset:2048
    ds_write_b128 v4, v[108:111] offset:3072
    ds_write_b128 v4, v[112:115] offset:4096
    ds_write_b128 v4, v[116:119] offset:5120
    ds_write_b128 v4, v[120:123] offset:6144
    ds_write_b128 v4, v[124:127] offset:7168
    s_waitcnt lgkmcnt(8)
    s_add_u32 s7, s27, 393216
    s_add_u32 m0, s28, 0
    s_add_u32 s3, s7, 0
    buffer_load_dwordx4 v60, s[12:15], s3 offen lds
    s_add_u32 m0, s28, 1024
    s_add_u32 s3, s7, 32768
    buffer_load_dwordx4 v60, s[12:15], s3 offen lds
    s_add_u32 m0, s28, 2048
    s_add_u32 s3, s7, 65536
    buffer_load_dwordx4 v60, s[12:15], s3 offen lds
    s_add_u32 m0, s28, 3072
    s_add_u32 s3, s7, 98304
    buffer_load_dwordx4 v60, s[12:15], s3 offen lds
    s_waitcnt lgkmcnt(0)
    s_add_u32 s7, s27, 524288
    s_add_u32 m0, s28, 4096
    s_add_u32 s3, s7, 0
    buffer_load_dwordx4 v60, s[12:15], s3 offen lds
    s_add_u32 m0, s28, 5120
    s_add_u32 s3, s7, 32768
    buffer_load_dwordx4 v60, s[12:15], s3 offen lds
    s_add_u32 m0, s28, 6144
    s_add_u32 s3, s7, 65536
    buffer_load_dwordx4 v60, s[12:15], s3 offen lds
    s_add_u32 m0, s28, 7168
    s_add_u32 s3, s7, 98304
    buffer_load_dwordx4 v60, s[12:15], s3 offen lds
    s_barrier
    v_add_u32 v7, 32768, v5
    ds_read_b128 v[64:67], v5 offset:0
    ds_read_b128 v[68:71], v5 offset:8192
    ds_read_b128 v[72:75], v5 offset:16384
    ds_read_b128 v[76:79], v5 offset:24576
    ds_read_b128 v[80:83], v7 offset:0
    ds_read_b128 v[84:87], v7 offset:8192
    ds_read_b128 v[88:91], v7 offset:16384
    ds_read_b128 v[92:95], v7 offset:24576
    s_add_u32 s7, s27, 655360
    s_add_u32 m0, s28, 8192
    s_add_u32 s3, s7, 0
    buffer_load_dwordx4 v60, s[12:15], s3 offen lds
    s_add_u32 m0, s28, 9216
    s_add_u32 s3, s7, 32768
    buffer_load_dwordx4 v60, s[12:15], s3 offen lds
    s_add_u32 m0, s28, 10240
    s_add_u32 s3, s7, 65536
    buffer_load_dwordx4 v60, s[12:15], s3 offen lds
    s_add_u32 m0, s28, 11264
    s_add_u32 s3, s7, 98304
    buffer_load_dwordx4 v60, s[12:15], s3 offen lds
    s_waitcnt lgkmcnt(0)
    v_add_f32 v64, v64, v80
    v_add_f32 v65, v65, v81
    v_add_f32 v66, v66, v82
    v_add_f32 v67, v67, v83
    v_add_f32 v68, v68, v84
    v_add_f32 v69, v69, v85
    v_add_f32 v70, v70, v86
    v_add_f32 v71, v71, v87
    v_add_f32 v72, v72, v88
    v_add_f32 v73, v73, v89
    v_add_f32 v74, v74, v90
    v_add_f32 v75, v75, v91
    v_add_f32 v76, v76, v92
    v_add_f32 v77, v77, v93
    v_add_f32 v78, v78, v94
    v_add_f32 v79, v79, v95
    v_add_f32 v64, v64, v72
    v_add_f32 v65, v65, v73
    v_add_f32 v66, v66, v74
    v_add_f32 v67, v67, v75
    v_add_f32 v68, v68, v76
    v_add_f32 v69, v69, v77
    v_add_f32 v70, v70, v78
    v_add_f32 v71, v71, v79
    v_add_f32 v64, v64, v68
    v_add_f32 v65, v65, v69
    v_add_f32 v66, v66, v70
    v_add_f32 v67, v67, v71
    v_cvt_pk_bf16_f32 v68, v64, v65
    v_cvt_pk_bf16_f32 v69, v66, v67
    v_lshlrev_b32 v64, 16, v68
    v_and_b32 v65, 0xffff0000, v68
    v_lshlrev_b32 v66, 16, v69
    v_and_b32 v67, 0xffff0000, v69
    v_lshlrev_b32 v70, 16, v12
    v_and_b32 v71, 0xffff0000, v12
    v_lshlrev_b32 v72, 16, v13
    v_and_b32 v73, 0xffff0000, v13
    v_add_f32 v64, v64, v70
    v_add_f32 v65, v65, v71
    v_add_f32 v66, v66, v72
    v_add_f32 v67, v67, v73
    v_cvt_pk_bf16_f32 v68, v64, v65
    v_cvt_pk_bf16_f32 v69, v66, v67
    v_lshlrev_b32 v64, 16, v68
    v_and_b32 v65, 0xffff0000, v68
    v_lshlrev_b32 v66, 16, v69
    v_and_b32 v67, 0xffff0000, v69
    s_mov_b32 s32, 0xbdd2d3e8
    v_mov_b32 v74, 0xc0135761
    v_mul_f32 v76, v64, v64
    v_mul_f32 v77, v65, v65
    v_mul_f32 v78, v66, v66
    v_mul_f32 v79, v67, v67
    v_fma_f32 v76, v76, s32, v74
    v_fma_f32 v77, v77, s32, v74
    v_fma_f32 v78, v78, s32, v74
    v_fma_f32 v79, v79, s32, v74
    v_mul_f32 v76, v76, v64
    v_mul_f32 v77, v77, v65
    v_mul_f32 v78, v78, v66
    v_mul_f32 v79, v79, v67
    v_exp_f32 v76, v76
    v_exp_f32 v77, v77
    v_exp_f32 v78, v78
    v_exp_f32 v79, v79
    v_add_f32 v76, 1.0, v76
    v_add_f32 v77, 1.0, v77
    v_add_f32 v78, 1.0, v78
    v_add_f32 v79, 1.0, v79
    v_rcp_f32 v76, v76
    v_rcp_f32 v77, v77
    v_rcp_f32 v78, v78
    v_rcp_f32 v79, v79
    v_mul_f32 v76, v76, v64
    v_mul_f32 v77, v77, v65
    v_mul_f32 v78, v78, v66
    v_mul_f32 v79, v79, v67
    v_cvt_pk_bf16_f32 v68, v76, v77
    v_cvt_pk_bf16_f32 v69, v78, v79
    v_min_u32 v10, s21, v68
    v_min_u32 v11, s21, v69
    buffer_store_dwordx2 v[8:9], v6, s[8:11], s30 offen offset:0 sc1
    buffer_store_dwordx2 v[10:11], v6, s[8:11], s30 offen offset:512 sc1
    s_barrier
    s_lshl_b32 s35, s6, 13
    s_mov_b32 s34, s28
    s_mov_b32 s28, s35
    s_add_u32 s7, s27, 786432
    s_add_u32 m0, s28, 0
    s_add_u32 s3, s7, 0
    buffer_load_dwordx4 v60, s[12:15], s3 offen lds
    s_add_u32 m0, s28, 1024
    s_add_u32 s3, s7, 32768
    buffer_load_dwordx4 v60, s[12:15], s3 offen lds
    s_add_u32 m0, s28, 2048
    s_add_u32 s3, s7, 65536
    buffer_load_dwordx4 v60, s[12:15], s3 offen lds
    s_add_u32 m0, s28, 3072
    s_add_u32 s3, s7, 98304
    buffer_load_dwordx4 v60, s[12:15], s3 offen lds
    s_mov_b32 s28, s34
    s_branch Ljoin_fused_kernel_92
Lskip1_fused_kernel_16:
    s_barrier
    s_mul_i32 s3, s6, 224
    s_add_u32 s3, s3, 128
    s_sub_u32 s7, s5, 28
    s_mul_i32 s7, s7, 24
    s_add_u32 s3, s3, s7
    v_lshrrev_b32 v16, 2, v1
    v_add_u32 v16, s3, v16
    v_lshlrev_b32 v16, 12, v16
    v_and_b32 v17, 3, v1
    v_lshl_add_u32 v16, v17, 7, v16
    s_lshl_b32 s3, s4, 9
    v_add_u32 v16, s3, v16
    global_load_dword v254, v16, s[60:61]
    v_add_u32 v16, 65536, v16
    s_mov_b32 exec_hi, 0
    global_load_dword v253, v16, s[60:61]
    s_mov_b64 exec, -1
    s_mov_b32 s12, s60
    s_mov_b32 s13, s61
    s_mov_b32 s14, 7340032
    s_mov_b32 s15, 0x20000
    v_lshrrev_b32 v40, 3, v1
    v_and_b32 v41, 7, v1
    v_bfe_u32 v42, v40, 1, 1
    v_lshlrev_b32 v42, 2, v42
    v_xor_b32 v41, v41, v42
    v_mul_u32_u24 v40, 4096, v40
    v_lshl_add_u32 v60, v41, 4, v40
    s_mul_i32 s27, s6, 917504
    s_lshl_b32 s3, s72, 7
    s_add_u32 s27, s27, s3
    v_lshrrev_b32 v41, 4, v1
    v_bfe_u32 v42, v1, 2, 2
    v_and_b32 v43, 3, v1
    v_lshrrev_b32 v44, 1, v41
    v_lshl_add_u32 v44, v44, 3, v42
    v_lshlrev_b32 v44, 7, v44
    v_and_b32 v45, 1, v41
    v_lshlrev_b32 v45, 1, v45
    v_lshrrev_b32 v46, 1, v43
    v_add_u32 v45, v45, v46
    v_bfe_u32 v46, v42, 1, 1
    v_lshl_add_u32 v45, v46, 2, v45
    v_lshl_add_u32 v44, v45, 4, v44
    v_and_b32 v46, 1, v43
    v_lshl_add_u32 v61, v46, 3, v44
    s_mul_i32 s28, s6, 12288
    s_add_u32 s28, s28, 65536
    v_add_u32 v62, s28, v61
    v_xor_b32 v63, 64, v62
    s_add_u32 s7, s27, 0
    s_add_u32 m0, s28, 0
    s_add_u32 s3, s7, 0
    buffer_load_dwordx4 v60, s[12:15], s3 offen lds
    s_add_u32 m0, s28, 1024
    s_add_u32 s3, s7, 32768
    buffer_load_dwordx4 v60, s[12:15], s3 offen lds
    s_add_u32 m0, s28, 2048
    s_add_u32 s3, s7, 65536
    buffer_load_dwordx4 v60, s[12:15], s3 offen lds
    s_add_u32 m0, s28, 3072
    s_add_u32 s3, s7, 98304
    buffer_load_dwordx4 v60, s[12:15], s3 offen lds
    s_add_u32 s7, s27, 131072
    s_add_u32 m0, s28, 4096
    s_add_u32 s3, s7, 0
    buffer_load_dwordx4 v60, s[12:15], s3 offen lds
    s_add_u32 m0, s28, 5120
    s_add_u32 s3, s7, 32768
    buffer_load_dwordx4 v60, s[12:15], s3 offen lds
    s_add_u32 m0, s28, 6144
    s_add_u32 s3, s7, 65536
    buffer_load_dwordx4 v60, s[12:15], s3 offen lds
    s_add_u32 m0, s28, 7168
    s_add_u32 s3, s7, 98304
    buffer_load_dwordx4 v60, s[12:15], s3 offen lds
    s_add_u32 s7, s27, 262144
    s_add_u32 m0, s28, 8192
    s_add_u32 s3, s7, 0
    buffer_load_dwordx4 v60, s[12:15], s3 offen lds
    s_add_u32 m0, s28, 9216
    s_add_u32 s3, s7, 32768
    buffer_load_dwordx4 v60, s[12:15], s3 offen lds
    s_add_u32 m0, s28, 10240
    s_add_u32 s3, s7, 65536
    buffer_load_dwordx4 v60, s[12:15], s3 offen lds
    s_add_u32 m0, s28, 11264
    s_add_u32 s3, s7, 98304
    buffer_load_dwordx4 v60, s[12:15], s3 offen lds
    s_waitcnt vmcnt(0)
    ds_read_b64_tr_b16 v[128:129], v62 offset:0
    ds_read_b64_tr_b16 v[130:131], v62 offset:512
    ds_read_b64_tr_b16 v[132:133], v63 offset:0
    ds_read_b64_tr_b16 v[134:135], v63 offset:512
    ds_read_b64_tr_b16 v[136:137], v62 offset:2048
    ds_read_b64_tr_b16 v[138:139], v62 offset:2560
    ds_read_b64_tr_b16 v[140:141], v63 offset:2048
    ds_read_b64_tr_b16 v[142:143], v63 offset:2560
    ds_read_b64_tr_b16 v[144:145], v62 offset:4096
    ds_read_b64_tr_b16 v[146:147], v62 offset:4608
    ds_read_b64_tr_b16 v[148:149], v63 offset:4096
    ds_read_b64_tr_b16 v[150:151], v63 offset:4608
    ds_read_b64_tr_b16 v[152:153], v62 offset:6144
    ds_read_b64_tr_b16 v[154:155], v62 offset:6656
    ds_read_b64_tr_b16 v[156:157], v63 offset:6144
    ds_read_b64_tr_b16 v[158:159], v63 offset:6656
    ds_read_b64_tr_b16 v[160:161], v62 offset:8192
    ds_read_b64_tr_b16 v[162:163], v62 offset:8704
    ds_read_b64_tr_b16 v[164:165], v63 offset:8192
    ds_read_b64_tr_b16 v[166:167], v63 offset:8704
    ds_read_b64_tr_b16 v[168:169], v62 offset:10240
    ds_read_b64_tr_b16 v[170:171], v62 offset:10752
    ds_read_b64_tr_b16 v[172:173], v63 offset:10240
    ds_read_b64_tr_b16 v[174:175], v63 offset:10752
    s_waitcnt lgkmcnt(0)
    s_add_u32 s7, s27, 393216
    s_add_u32 m0, s28, 0
    s_add_u32 s3, s7, 0
    buffer_load_dwordx4 v60, s[12:15], s3 offen lds
    s_add_u32 m0, s28, 1024
    s_add_u32 s3, s7, 32768
    buffer_load_dwordx4 v60, s[12:15], s3 offen lds
    s_add_u32 m0, s28, 2048
    s_add_u32 s3, s7, 65536
    buffer_load_dwordx4 v60, s[12:15], s3 offen lds
    s_add_u32 m0, s28, 3072
    s_add_u32 s3, s7, 98304
    buffer_load_dwordx4 v60, s[12:15], s3 offen lds
    s_add_u32 s7, s27, 524288
    s_add_u32 m0, s28, 4096
    s_add_u32 s3, s7, 0
    buffer_load_dwordx4 v60, s[12:15], s3 offen lds
    s_add_u32 m0, s28, 5120
    s_add_u32 s3, s7, 32768
    buffer_load_dwordx4 v60, s[12:15], s3 offen lds
    s_add_u32 m0, s28, 6144
    s_add_u32 s3, s7, 65536
    buffer_load_dwordx4 v60, s[12:15], s3 offen lds
    s_add_u32 m0, s28, 7168
    s_add_u32 s3, s7, 98304
    buffer_load_dwordx4 v60, s[12:15], s3 offen lds
    s_add_u32 s7, s27, 655360
    s_add_u32 m0, s28, 8192
    s_add_u32 s3, s7, 0
    buffer_load_dwordx4 v60, s[12:15], s3 offen lds
    s_add_u32 m0, s28, 9216
    s_add_u32 s3, s7, 32768
    buffer_load_dwordx4 v60, s[12:15], s3 offen lds
    s_add_u32 m0, s28, 10240
    s_add_u32 s3, s7, 65536
    buffer_load_dwordx4 v60, s[12:15], s3 offen lds
    s_add_u32 m0, s28, 11264
    s_add_u32 s3, s7, 98304
    buffer_load_dwordx4 v60, s[12:15], s3 offen lds
    s_lshl_b32 s35, s6, 13
    s_mov_b32 s34, s28
    s_mov_b32 s28, s35
    s_add_u32 s7, s27, 786432
    s_add_u32 m0, s28, 0
    s_add_u32 s3, s7, 0
    buffer_load_dwordx4 v60, s[12:15], s3 offen lds
    s_add_u32 m0, s28, 1024
    s_add_u32 s3, s7, 32768
    buffer_load_dwordx4 v60, s[12:15], s3 offen lds
    s_add_u32 m0, s28, 2048
    s_add_u32 s3, s7, 65536
    buffer_load_dwordx4 v60, s[12:15], s3 offen lds
    s_add_u32 m0, s28, 3072
    s_add_u32 s3, s7, 98304
    buffer_load_dwordx4 v60, s[12:15], s3 offen lds
    s_mov_b32 s28, s34
Ljoin_fused_kernel_92:
    v_mov_b32 v59, s35
    v_lshrrev_b32 v3, 5, v1
    v_lshlrev_b32 v3, 13, v3
    v_and_b32 v4, 31, v1
    v_lshl_add_u32 v3, v4, 4, v3
    s_mul_i32 s29, s6, 229376
    s_lshl_b32 s30, s19, 10
    s_add_u32 s29, s29, s30
    s_add_u32 s29, s29, 14680064
    v_lshrrev_b32 v4, 5, v1
    v_mul_u32_u24 v4, 1088, v4
    v_and_b32 v5, 31, v1
    v_lshl_add_u32 v4, v5, 4, v4
    s_mul_i32 s31, s6, 8704
    v_add_u32 v4, s31, v4
    v_and_b32 v6, 7, v0
    v_mul_u32_u24 v5, 1088, v6
    v_lshrrev_b32 v7, 3, v0
    v_lshl_add_u32 v5, v7, 4, v5
    v_lshlrev_b32 v8, 11, v7
    v_and_b32 v9, 1, v6
    v_lshl_add_u32 v8, v9, 10, v8
    v_lshrrev_b32 v9, 1, v6
    v_lshl_add_u32 v8, v9, 4, v8
    v_lshlrev_b32 v9, 1, v7
    s_lshl_b32 s31, s72, 7
    v_add_u32 v9, s31, v9
    global_load_ushort v11, v9, s[62:63]
    v_lshlrev_b32 v7, 10, v7
    v_lshl_add_u32 v6, v6, 3, v7
    s_lshl_b32 s30, s72, 16
    s_lshl_b32 s33, s19, 7
    s_add_u32 s30, s30, s33
    s_lshl_b32 s33, s72, 17
    s_lshl_b32 s34, s19, 7
    s_add_u32 s33, s33, s34
    s_add_u32 s33, s33, 8388608
    buffer_load_dwordx4 v[48:51], v8, s[8:11], s33 offen sc1
    buffer_load_dwordx4 v[52:55], v8, s[8:11], s33 offen offset:64 sc1
    s_cmp_eq_u32 s73, 7
    s_cbranch_scc1 Lact_fused_kernel_93
    s_waitcnt vmcnt(9)
    s_branch Lj_fused_kernel_94
Lact_fused_kernel_93:
    s_waitcnt vmcnt(7)
Lj_fused_kernel_94:
    ds_read_b64_tr_b16 v[176:177], v62 offset:0
    ds_read_b64_tr_b16 v[178:179], v62 offset:512
    ds_read_b64_tr_b16 v[180:181], v63 offset:0
    ds_read_b64_tr_b16 v[182:183], v63 offset:512
    ds_read_b64_tr_b16 v[184:185], v62 offset:2048
    ds_read_b64_tr_b16 v[186:187], v62 offset:2560
    ds_read_b64_tr_b16 v[188:189], v63 offset:2048
    ds_read_b64_tr_b16 v[190:191], v63 offset:2560
    ds_read_b64_tr_b16 v[192:193], v62 offset:4096
    ds_read_b64_tr_b16 v[194:195], v62 offset:4608
    ds_read_b64_tr_b16 v[196:197], v63 offset:4096
    ds_read_b64_tr_b16 v[198:199], v63 offset:4608
    ds_read_b64_tr_b16 v[200:201], v62 offset:6144
    ds_read_b64_tr_b16 v[202:203], v62 offset:6656
    ds_read_b64_tr_b16 v[204:205], v63 offset:6144
    ds_read_b64_tr_b16 v[206:207], v63 offset:6656
    ds_read_b64_tr_b16 v[208:209], v62 offset:8192
    ds_read_b64_tr_b16 v[210:211], v62 offset:8704
    ds_read_b64_tr_b16 v[212:213], v63 offset:8192
    ds_read_b64_tr_b16 v[214:215], v63 offset:8704
    ds_read_b64_tr_b16 v[216:217], v62 offset:10240
    ds_read_b64_tr_b16 v[218:219], v62 offset:10752
    ds_read_b64_tr_b16 v[220:221], v63 offset:10240
    ds_read_b64_tr_b16 v[222:223], v63 offset:10752
    v_add_u32 v62, v59, v61
    v_xor_b32 v63, 64, v62
    s_waitcnt vmcnt(3)
    ds_read_b64_tr_b16 v[224:225], v62 offset:0
    ds_read_b64_tr_b16 v[226:227], v62 offset:512
    ds_read_b64_tr_b16 v[228:229], v63 offset:0
    ds_read_b64_tr_b16 v[230:231], v63 offset:512
    ds_read_b64_tr_b16 v[232:233], v62 offset:2048
    ds_read_b64_tr_b16 v[234:235], v62 offset:2560
    ds_read_b64_tr_b16 v[236:237], v63 offset:2048
    ds_read_b64_tr_b16 v[238:239], v63 offset:2560
    s_waitcnt lgkmcnt(0)
    s_barrier
    s_add_u32 s31, s29, 0
    s_mov_b32 s7, 0
Lval_fused_kernel_95:
    buffer_load_dwordx4 v[16:19], v3, s[8:11], s31 offen sc1
    s_add_u32 s7, s7, 1
    s_bitcmp1_b32 s7, 17
    s_cbranch_scc1 Lvalx_fused_kernel_96
    s_waitcnt vmcnt(0)
    s_mov_b64 exec, -1
    v_max3_u32 v2, v16, v17, v18
    v_max_u32 v2, v2, v19
    v_cmp_eq_u32 vcc, -1, v2
    s_mov_b64 exec, vcc
    s_cbranch_vccnz Lval_fused_kernel_95
Lvalx_fused_kernel_96:
    s_mov_b64 exec, -1
    s_waitcnt vmcnt(0)
    s_mov_b32 s7, 0
    s_waitcnt vmcnt(0)
    v_xor_b32 v56, s20, v50
    v_xor_b32 v57, s22, v51
    v_xor_b32 v58, s20, v54
    v_xor_b32 v59, s22, v55
    v_or3_b32 v56, v56, v57, v58
    v_or_b32 v56, v56, v59
    v_cmp_ne_u32 vcc, 0, v56
    s_cbranch_vccz Ltagc_fused_kernel_99
    s_mov_b64 exec, vcc
Ltag_fused_kernel_97:
    buffer_load_dwordx4 v[48:51], v8, s[8:11], s33 offen sc1
    buffer_load_dwordx4 v[52:55], v8, s[8:11], s33 offen offset:64 sc1
    s_add_u32 s7, s7, 1
    s_bitcmp1_b32 s7, 17
    s_cbranch_scc1 Ltagx_fused_kernel_98
    s_waitcnt vmcnt(0)
    s_mov_b64 exec, -1
    v_xor_b32 v56, s20, v50
    v_xor_b32 v57, s22, v51
    v_xor_b32 v58, s20, v54
    v_xor_b32 v59, s22, v55
    v_or3_b32 v56, v56, v57, v58
    v_or_b32 v56, v56, v59
    v_cmp_ne_u32 vcc, 0, v56
    s_mov_b64 exec, vcc
    s_cbranch_vccnz Ltag_fused_kernel_97
Ltagx_fused_kernel_98:
    s_mov_b64 exec, -1
    s_waitcnt vmcnt(0)
Ltagc_fused_kernel_99:
    v_mov_b32 v12, v48
    v_mov_b32 v13, v49
    v_mov_b32 v14, v52
    v_mov_b32 v15, v53
    s_mov_b32 s12, s64
    s_mov_b32 s13, s65
    s_mov_b32 s14, 2097152
    s_mov_b32 s15, 0x20000
    s_add_u32 s31, s29, 16384
    buffer_load_dwordx4 v[20:23], v3, s[8:11], s31 offen sc1
    s_add_u32 s31, s29, 32768
    buffer_load_dwordx4 v[24:27], v3, s[8:11], s31 offen sc1
    s_add_u32 s31, s29, 49152
    buffer_load_dwordx4 v[28:31], v3, s[8:11], s31 offen sc1
    s_add_u32 s31, s29, 65536
    buffer_load_dwordx4 v[32:35], v3, s[8:11], s31 offen sc1
    v_mfma_f32_32x32x16_bf16 v[64:79], v[16:19], v[128:131], 0
    v_mfma_f32_32x32x16_bf16 v[80:95], v[16:19], v[132:135], 0
    s_add_u32 s31, s29, 81920
    buffer_load_dwordx4 v[16:19], v3, s[8:11], s31 offen sc1
    s_waitcnt vmcnt(4)
Lchk_fused_kernel_100:
    v_max3_u32 v2, v20, v21, v22
    v_max_u32 v2, v2, v23
    v_cmp_eq_u32 vcc, -1, v2
    s_cbranch_vccnz Lstub_fused_kernel_101
    v_mfma_f32_32x32x16_bf16 v[64:79], v[20:23], v[136:139], v[64:79]
    v_mfma_f32_32x32x16_bf16 v[80:95], v[20:23], v[140:143], v[80:95]
    s_add_u32 s31, s29, 98304
    buffer_load_dwordx4 v[20:23], v3, s[8:11], s31 offen sc1
    s_waitcnt vmcnt(4)
Lchk_fused_kernel_102:
    v_max3_u32 v2, v24, v25, v26
    v_max_u32 v2, v2, v27
    v_cmp_eq_u32 vcc, -1, v2
    s_cbranch_vccnz Lstub_fused_kernel_103
    v_mfma_f32_32x32x16_bf16 v[64:79], v[24:27], v[144:147], v[64:79]
    v_mfma_f32_32x32x16_bf16 v[80:95], v[24:27], v[148:151], v[80:95]
    s_add_u32 s31, s29, 114688
    buffer_load_dwordx4 v[24:27], v3, s[8:11], s31 offen sc1
    s_waitcnt vmcnt(4)
Lchk_fused_kernel_104:
    v_max3_u32 v2, v28, v29, v30
    v_max_u32 v2, v2, v31
    v_cmp_eq_u32 vcc, -1, v2
    s_cbranch_vccnz Lstub_fused_kernel_105
    v_mfma_f32_32x32x16_bf16 v[64:79], v[28:31], v[152:155], v[64:79]
    v_mfma_f32_32x32x16_bf16 v[80:95], v[28:31], v[156:159], v[80:95]
    s_add_u32 s31, s29, 131072
    buffer_load_dwordx4 v[28:31], v3, s[8:11], s31 offen sc1
    s_waitcnt vmcnt(4)
Lchk_fused_kernel_106:
    v_max3_u32 v2, v32, v33, v34
    v_max_u32 v2, v2, v35
    v_cmp_eq_u32 vcc, -1, v2
    s_cbranch_vccnz Lstub_fused_kernel_107
    v_mfma_f32_32x32x16_bf16 v[64:79], v[32:35], v[160:163], v[64:79]
    v_mfma_f32_32x32x16_bf16 v[80:95], v[32:35], v[164:167], v[80:95]
    s_add_u32 s31, s29, 147456
    buffer_load_dwordx4 v[32:35], v3, s[8:11], s31 offen sc1
    s_waitcnt vmcnt(4)
Lchk_fused_kernel_108:
    v_max3_u32 v2, v16, v17, v18
    v_max_u32 v2, v2, v19
    v_cmp_eq_u32 vcc, -1, v2
    s_cbranch_vccnz Lstub_fused_kernel_109
    v_mfma_f32_32x32x16_bf16 v[64:79], v[16:19], v[168:171], v[64:79]
    v_mfma_f32_32x32x16_bf16 v[80:95], v[16:19], v[172:175], v[80:95]
    s_add_u32 s31, s29, 163840
    buffer_load_dwordx4 v[16:19], v3, s[8:11], s31 offen sc1
    s_waitcnt vmcnt(4)
Lchk_fused_kernel_110:
    v_max3_u32 v2, v20, v21, v22
    v_max_u32 v2, v2, v23
    v_cmp_eq_u32 vcc, -1, v2
    s_cbranch_vccnz Lstub_fused_kernel_111
    v_mfma_f32_32x32x16_bf16 v[64:79], v[20:23], v[176:179], v[64:79]
    v_mfma_f32_32x32x16_bf16 v[80:95], v[20:23], v[180:183], v[80:95]
    s_add_u32 s31, s29, 180224
    buffer_load_dwordx4 v[20:23], v3, s[8:11], s31 offen sc1
    s_waitcnt vmcnt(4)
Lchk_fused_kernel_112:
    v_max3_u32 v2, v24, v25, v26
    v_max_u32 v2, v2, v27
    v_cmp_eq_u32 vcc, -1, v2
    s_cbranch_vccnz Lstub_fused_kernel_113
    v_mfma_f32_32x32x16_bf16 v[64:79], v[24:27], v[184:187], v[64:79]
    v_mfma_f32_32x32x16_bf16 v[80:95], v[24:27], v[188:191], v[80:95]
    s_add_u32 s31, s29, 196608
    buffer_load_dwordx4 v[24:27], v3, s[8:11], s31 offen sc1
    s_waitcnt vmcnt(4)
Lchk_fused_kernel_114:
    v_max3_u32 v2, v28, v29, v30
    v_max_u32 v2, v2, v31
    v_cmp_eq_u32 vcc, -1, v2
    s_cbranch_vccnz Lstub_fused_kernel_115
    v_mfma_f32_32x32x16_bf16 v[64:79], v[28:31], v[192:195], v[64:79]
    v_mfma_f32_32x32x16_bf16 v[80:95], v[28:31], v[196:199], v[80:95]
    s_add_u32 s31, s29, 212992
    buffer_load_dwordx4 v[28:31], v3, s[8:11], s31 offen sc1
    s_waitcnt vmcnt(4)
Lchk_fused_kernel_116:
    v_max3_u32 v2, v32, v33, v34
    v_max_u32 v2, v2, v35
    v_cmp_eq_u32 vcc, -1, v2
    s_cbranch_vccnz Lstub_fused_kernel_117
    v_mfma_f32_32x32x16_bf16 v[64:79], v[32:35], v[200:203], v[64:79]
    v_mfma_f32_32x32x16_bf16 v[80:95], v[32:35], v[204:207], v[80:95]
    s_add_u32 s31, s29, 512
    buffer_load_dwordx4 v[32:35], v3, s[8:11], s31 offen sc1
    s_waitcnt vmcnt(4)
Lchk_fused_kernel_118:
    v_max3_u32 v2, v16, v17, v18
    v_max_u32 v2, v2, v19
    v_cmp_eq_u32 vcc, -1, v2
    s_cbranch_vccnz Lstub_fused_kernel_119
    v_mfma_f32_32x32x16_bf16 v[64:79], v[16:19], v[208:211], v[64:79]
    v_mfma_f32_32x32x16_bf16 v[80:95], v[16:19], v[212:215], v[80:95]
    s_add_u32 s31, s29, 16896
    buffer_load_dwordx4 v[16:19], v3, s[8:11], s31 offen sc1
    s_waitcnt vmcnt(4)
Lchk_fused_kernel_120:
    v_max3_u32 v2, v20, v21, v22
    v_max_u32 v2, v2, v23
    v_cmp_eq_u32 vcc, -1, v2
    s_cbranch_vccnz Lstub_fused_kernel_121
    v_mfma_f32_32x32x16_bf16 v[64:79], v[20:23], v[216:219], v[64:79]
    v_mfma_f32_32x32x16_bf16 v[80:95], v[20:23], v[220:223], v[80:95]
    s_add_u32 s31, s29, 33280
    buffer_load_dwordx4 v[20:23], v3, s[8:11], s31 offen sc1
    s_waitcnt vmcnt(4)
Lchk_fused_kernel_122:
    v_max3_u32 v2, v24, v25, v26
    v_max_u32 v2, v2, v27
    v_cmp_eq_u32 vcc, -1, v2
    s_cbranch_vccnz Lstub_fused_kernel_123
    v_mfma_f32_32x32x16_bf16 v[64:79], v[24:27], v[224:227], v[64:79]
    v_mfma_f32_32x32x16_bf16 v[80:95], v[24:27], v[228:231], v[80:95]
    s_add_u32 s31, s29, 49664
    buffer_load_dwordx4 v[24:27], v3, s[8:11], s31 offen sc1
    s_waitcnt vmcnt(4)
Lchk_fused_kernel_124:
    v_max3_u32 v2, v28, v29, v30
    v_max_u32 v2, v2, v31
    v_cmp_eq_u32 vcc, -1, v2
    s_cbranch_vccnz Lstub_fused_kernel_125
    v_mfma_f32_32x32x16_bf16 v[64:79], v[28:31], v[232:235], v[64:79]
    v_mfma_f32_32x32x16_bf16 v[80:95], v[28:31], v[236:239], v[80:95]
    s_add_u32 s31, s29, 66048
    buffer_load_dwordx4 v[28:31], v3, s[8:11], s31 offen sc1
    s_waitcnt vmcnt(4)
Lchk_fused_kernel_126:
    v_max3_u32 v2, v32, v33, v34
    v_max_u32 v2, v2, v35
    v_cmp_eq_u32 vcc, -1, v2
    s_cbranch_vccnz Lstub_fused_kernel_127
    v_mfma_f32_32x32x16_bf16 v[96:111], v[32:35], v[128:131], 0
    v_mfma_f32_32x32x16_bf16 v[112:127], v[32:35], v[132:135], 0
    s_add_u32 s31, s29, 82432
    buffer_load_dwordx4 v[32:35], v3, s[8:11], s31 offen sc1
    s_waitcnt vmcnt(4)
Lchk_fused_kernel_128:
    v_max3_u32 v2, v16, v17, v18
    v_max_u32 v2, v2, v19
    v_cmp_eq_u32 vcc, -1, v2
    s_cbranch_vccnz Lstub_fused_kernel_129
    v_mfma_f32_32x32x16_bf16 v[96:111], v[16:19], v[136:139], v[96:111]
    v_mfma_f32_32x32x16_bf16 v[112:127], v[16:19], v[140:143], v[112:127]
    s_add_u32 s31, s29, 98816
    buffer_load_dwordx4 v[16:19], v3, s[8:11], s31 offen sc1
    ds_write_b128 v4, v[64:67] offset:0
    ds_write_b128 v4, v[68:71] offset:2176
    s_waitcnt vmcnt(4)
Lchk_fused_kernel_130:
    v_max3_u32 v2, v20, v21, v22
    v_max_u32 v2, v2, v23
    v_cmp_eq_u32 vcc, -1, v2
    s_cbranch_vccnz Lstub_fused_kernel_131
    v_mfma_f32_32x32x16_bf16 v[96:111], v[20:23], v[144:147], v[96:111]
    v_mfma_f32_32x32x16_bf16 v[112:127], v[20:23], v[148:151], v[112:127]
    s_add_u32 s31, s29, 115200
    buffer_load_dwordx4 v[20:23], v3, s[8:11], s31 offen sc1
    ds_write_b128 v4, v[72:75] offset:4352
    ds_write_b128 v4, v[76:79] offset:6528
    s_waitcnt vmcnt(4)
Lchk_fused_kernel_132:
    v_max3_u32 v2, v24, v25, v26
    v_max_u32 v2, v2, v27
    v_cmp_eq_u32 vcc, -1, v2
    s_cbranch_vccnz Lstub_fused_kernel_133
    v_mfma_f32_32x32x16_bf16 v[96:111], v[24:27], v[152:155], v[96:111]
    v_mfma_f32_32x32x16_bf16 v[112:127], v[24:27], v[156:159], v[112:127]
    s_add_u32 s31, s29, 131584
    buffer_load_dwordx4 v[24:27], v3, s[8:11], s31 offen sc1
    ds_write_b128 v4, v[80:83] offset:512
    ds_write_b128 v4, v[84:87] offset:2688
    s_waitcnt vmcnt(4)
Lchk_fused_kernel_134:
    v_max3_u32 v2, v28, v29, v30
    v_max_u32 v2, v2, v31
    v_cmp_eq_u32 vcc, -1, v2
    s_cbranch_vccnz Lstub_fused_kernel_135
    v_mfma_f32_32x32x16_bf16 v[96:111], v[28:31], v[160:163], v[96:111]
    v_mfma_f32_32x32x16_bf16 v[112:127], v[28:31], v[164:167], v[112:127]
    s_add_u32 s31, s29, 147968
    buffer_load_dwordx4 v[28:31], v3, s[8:11], s31 offen sc1
    ds_write_b128 v4, v[88:91] offset:4864
    ds_write_b128 v4, v[92:95] offset:7040
    s_waitcnt vmcnt(4)
Lchk_fused_kernel_136:
    v_max3_u32 v2, v32, v33, v34
    v_max_u32 v2, v2, v35
    v_cmp_eq_u32 vcc, -1, v2
    s_cbranch_vccnz Lstub_fused_kernel_137
    v_mfma_f32_32x32x16_bf16 v[96:111], v[32:35], v[168:171], v[96:111]
    v_mfma_f32_32x32x16_bf16 v[112:127], v[32:35], v[172:175], v[112:127]
    s_add_u32 s31, s29, 164352
    buffer_load_dwordx4 v[32:35], v3, s[8:11], s31 offen sc1
    s_waitcnt vmcnt(4)
Lchk_fused_kernel_138:
    v_max3_u32 v2, v16, v17, v18
    v_max_u32 v2, v2, v19
    v_cmp_eq_u32 vcc, -1, v2
    s_cbranch_vccnz Lstub_fused_kernel_139
    v_mfma_f32_32x32x16_bf16 v[96:111], v[16:19], v[176:179], v[96:111]
    v_mfma_f32_32x32x16_bf16 v[112:127], v[16:19], v[180:183], v[112:127]
    s_add_u32 s31, s29, 180736
    buffer_load_dwordx4 v[16:19], v3, s[8:11], s31 offen sc1
    s_waitcnt lgkmcnt(0)
    s_barrier
    v_add_u32 v7, 34816, v5
    ds_read_b128 v[64:67], v5 offset:0
    ds_read_b128 v[68:71], v5 offset:8704
    ds_read_b128 v[72:75], v5 offset:17408
    ds_read_b128 v[76:79], v5 offset:26112
    ds_read_b128 v[80:83], v7 offset:0
    ds_read_b128 v[84:87], v7 offset:8704
    ds_read_b128 v[88:91], v7 offset:17408
    ds_read_b128 v[92:95], v7 offset:26112
    s_waitcnt vmcnt(4)
Lchk_fused_kernel_140:
    v_max3_u32 v2, v20, v21, v22
    v_max_u32 v2, v2, v23
    v_cmp_eq_u32 vcc, -1, v2
    s_cbranch_vccnz Lstub_fused_kernel_141
    v_mfma_f32_32x32x16_bf16 v[96:111], v[20:23], v[184:187], v[96:111]
    v_mfma_f32_32x32x16_bf16 v[112:127], v[20:23], v[188:191], v[112:127]
    s_add_u32 s31, s29, 197120
    buffer_load_dwordx4 v[20:23], v3, s[8:11], s31 offen sc1
    s_waitcnt vmcnt(4)
Lchk_fused_kernel_142:
    v_max3_u32 v2, v24, v25, v26
    v_max_u32 v2, v2, v27
    v_cmp_eq_u32 vcc, -1, v2
    s_cbranch_vccnz Lstub_fused_kernel_143
    v_mfma_f32_32x32x16_bf16 v[96:111], v[24:27], v[192:195], v[96:111]
    v_mfma_f32_32x32x16_bf16 v[112:127], v[24:27], v[196:199], v[112:127]
    s_add_u32 s31, s29, 213504
    buffer_load_dwordx4 v[24:27], v3, s[8:11], s31 offen sc1
    s_waitcnt lgkmcnt(0)
    v_add_f32 v64, v64, v80
    v_add_f32 v65, v65, v81
    v_add_f32 v66, v66, v82
    v_add_f32 v67, v67, v83
    v_add_f32 v68, v68, v84
    v_add_f32 v69, v69, v85
    v_add_f32 v70, v70, v86
    v_add_f32 v71, v71, v87
    v_add_f32 v72, v72, v88
    s_waitcnt vmcnt(4)
Lchk_fused_kernel_144:
    v_max3_u32 v2, v28, v29, v30
    v_max_u32 v2, v2, v31
    v_cmp_eq_u32 vcc, -1, v2
    s_cbranch_vccnz Lstub_fused_kernel_145
    v_mfma_f32_32x32x16_bf16 v[96:111], v[28:31], v[200:203], v[96:111]
    v_mfma_f32_32x32x16_bf16 v[112:127], v[28:31], v[204:207], v[112:127]
    v_add_f32 v73, v73, v89
    v_add_f32 v74, v74, v90
    v_add_f32 v75, v75, v91
    v_add_f32 v76, v76, v92
    v_add_f32 v77, v77, v93
    v_add_f32 v78, v78, v94
    v_add_f32 v79, v79, v95
    v_add_f32 v64, v64, v72
    v_add_f32 v65, v65, v73
    s_waitcnt vmcnt(3)
Lchk_fused_kernel_146:
    v_max3_u32 v2, v32, v33, v34
    v_max_u32 v2, v2, v35
    v_cmp_eq_u32 vcc, -1, v2
    s_cbranch_vccnz Lstub_fused_kernel_147
    v_mfma_f32_32x32x16_bf16 v[96:111], v[32:35], v[208:211], v[96:111]
    v_mfma_f32_32x32x16_bf16 v[112:127], v[32:35], v[212:215], v[112:127]
    v_add_f32 v66, v66, v74
    v_add_f32 v67, v67, v75
    v_add_f32 v68, v68, v76
    v_add_f32 v69, v69, v77
    v_add_f32 v70, v70, v78
    v_add_f32 v71, v71, v79
    v_add_f32 v64, v64, v68
    v_add_f32 v65, v65, v69
    v_add_f32 v66, v66, v70
    s_waitcnt vmcnt(2)
Lchk_fused_kernel_148:
    v_max3_u32 v2, v16, v17, v18
    v_max_u32 v2, v2, v19
    v_cmp_eq_u32 vcc, -1, v2
    s_cbranch_vccnz Lstub_fused_kernel_149
    v_mfma_f32_32x32x16_bf16 v[96:111], v[16:19], v[216:219], v[96:111]
    v_mfma_f32_32x32x16_bf16 v[112:127], v[16:19], v[220:223], v[112:127]
    v_add_f32 v67, v67, v71
    v_cvt_pk_bf16_f32 v68, v64, v65
    v_cvt_pk_bf16_f32 v69, v66, v67
    v_lshlrev_b32 v64, 16, v68
    v_and_b32 v65, 0xffff0000, v68
    v_lshlrev_b32 v66, 16, v69
    v_and_b32 v67, 0xffff0000, v69
    v_lshlrev_b32 v70, 16, v11
    v_add_f32 v64, v64, v70
    s_waitcnt vmcnt(1)
Lchk_fused_kernel_150:
    v_max3_u32 v2, v20, v21, v22
    v_max_u32 v2, v2, v23
    v_cmp_eq_u32 vcc, -1, v2
    s_cbranch_vccnz Lstub_fused_kernel_151
    v_mfma_f32_32x32x16_bf16 v[96:111], v[20:23], v[224:227], v[96:111]
    v_mfma_f32_32x32x16_bf16 v[112:127], v[20:23], v[228:231], v[112:127]
    v_add_f32 v65, v65, v70
    v_add_f32 v66, v66, v70
    v_add_f32 v67, v67, v70
    v_cvt_pk_bf16_f32 v68, v64, v65
    v_cvt_pk_bf16_f32 v69, v66, v67
    v_lshlrev_b32 v64, 16, v68
    v_and_b32 v65, 0xffff0000, v68
    v_lshlrev_b32 v70, 16, v12
    v_and_b32 v71, 0xffff0000, v12
    s_waitcnt vmcnt(0)
Lchk_fused_kernel_152:
    v_max3_u32 v2, v24, v25, v26
    v_max_u32 v2, v2, v27
    v_cmp_eq_u32 vcc, -1, v2
    s_cbranch_vccnz Lstub_fused_kernel_153
    v_mfma_f32_32x32x16_bf16 v[96:111], v[24:27], v[232:235], v[96:111]
    v_mfma_f32_32x32x16_bf16 v[112:127], v[24:27], v[236:239], v[112:127]
    v_lshlrev_b32 v66, 16, v69
    v_and_b32 v67, 0xffff0000, v69
    v_lshlrev_b32 v72, 16, v13
    v_and_b32 v73, 0xffff0000, v13
    v_add_f32 v64, v64, v70
    v_add_f32 v65, v65, v71
    v_add_f32 v66, v66, v72
    v_add_f32 v67, v67, v73
    v_cvt_pk_bf16_f32 v12, v64, v65
    v_cvt_pk_bf16_f32 v13, v66, v67
    s_barrier
    ds_write_b128 v4, v[96:99] offset:0
    ds_write_b128 v4, v[100:103] offset:2176
    ds_write_b128 v4, v[104:107] offset:4352
    ds_write_b128 v4, v[108:111] offset:6528
    ds_write_b128 v4, v[112:115] offset:512
    ds_write_b128 v4, v[116:119] offset:2688
    ds_write_b128 v4, v[120:123] offset:4864
    ds_write_b128 v4, v[124:127] offset:7040
    s_waitcnt lgkmcnt(0)
    s_barrier
    v_add_u32 v7, 34816, v5
    ds_read_b128 v[64:67], v5 offset:0
    ds_read_b128 v[68:71], v5 offset:8704
    ds_read_b128 v[72:75], v5 offset:17408
    ds_read_b128 v[76:79], v5 offset:26112
    ds_read_b128 v[80:83], v7 offset:0
    ds_read_b128 v[84:87], v7 offset:8704
    ds_read_b128 v[88:91], v7 offset:17408
    ds_read_b128 v[92:95], v7 offset:26112
    s_waitcnt lgkmcnt(0)
    v_add_f32 v64, v64, v80
    v_add_f32 v65, v65, v81
    v_add_f32 v66, v66, v82
    v_add_f32 v67, v67, v83
    v_add_f32 v68, v68, v84
    v_add_f32 v69, v69, v85
    v_add_f32 v70, v70, v86
    v_add_f32 v71, v71, v87
    v_add_f32 v72, v72, v88
    v_add_f32 v73, v73, v89
    v_add_f32 v74, v74, v90
    v_add_f32 v75, v75, v91
    v_add_f32 v76, v76, v92
    v_add_f32 v77, v77, v93
    v_add_f32 v78, v78, v94
    v_add_f32 v79, v79, v95
    v_add_f32 v64, v64, v72
    v_add_f32 v65, v65, v73
    v_add_f32 v66, v66, v74
    v_add_f32 v67, v67, v75
    v_add_f32 v68, v68, v76
    v_add_f32 v69, v69, v77
    v_add_f32 v70, v70, v78
    v_add_f32 v71, v71, v79
    v_add_f32 v64, v64, v68
    v_add_f32 v65, v65, v69
    v_add_f32 v66, v66, v70
    v_add_f32 v67, v67, v71
    v_cvt_pk_bf16_f32 v68, v64, v65
    v_cvt_pk_bf16_f32 v69, v66, v67
    v_lshlrev_b32 v64, 16, v68
    v_and_b32 v65, 0xffff0000, v68
    v_lshlrev_b32 v66, 16, v69
    v_and_b32 v67, 0xffff0000, v69
    v_lshlrev_b32 v70, 16, v11
    v_add_f32 v64, v64, v70
    v_add_f32 v65, v65, v70
    v_add_f32 v66, v66, v70
    v_add_f32 v67, v67, v70
    v_cvt_pk_bf16_f32 v68, v64, v65
    v_cvt_pk_bf16_f32 v69, v66, v67
    v_lshlrev_b32 v64, 16, v68
    v_and_b32 v65, 0xffff0000, v68
    v_lshlrev_b32 v70, 16, v14
    v_and_b32 v71, 0xffff0000, v14
    v_lshlrev_b32 v66, 16, v69
    v_and_b32 v67, 0xffff0000, v69
    v_lshlrev_b32 v72, 16, v15
    v_and_b32 v73, 0xffff0000, v15
    v_add_f32 v64, v64, v70
    v_add_f32 v65, v65, v71
    v_add_f32 v66, v66, v72
    v_add_f32 v67, v67, v73
    v_cvt_pk_bf16_f32 v14, v64, v65
    v_cvt_pk_bf16_f32 v15, v66, v67
    buffer_store_dwordx2 v[12:13], v6, s[12:15], s30 offen offset:0
    buffer_store_dwordx2 v[14:15], v6, s[12:15], s30 offen offset:64
    s_cmp_lg_u32 s2, 0
    s_cbranch_scc1 Lep_fused_kernel_154
    s_cmp_lg_u32 s6, 0
    s_cbranch_scc1 Lep_fused_kernel_154
    s_mov_b64 exec, 1
    v_mov_b32 v2, s20
    v_mov_b32 v3, 16777216
    buffer_store_dword v2, v3, s[8:11], 0 offen
    s_mov_b64 exec, -1
Lep_fused_kernel_154:
L_end_fused_kernel:
    s_endpgm
Lstub_fused_kernel_31:
    s_add_u32 s23, s23, 1
    s_bitcmp1_b32 s23, 20
    s_cbranch_scc1 L_end_fused_kernel
    s_add_u32 s31, s29, 16384
    buffer_load_dwordx4 v[20:23], v3, s[8:11], s31 offen sc1
    s_waitcnt vmcnt(0)
    s_branch Lchk_fused_kernel_30
Lstub_fused_kernel_33:
    s_add_u32 s23, s23, 1
    s_bitcmp1_b32 s23, 20
    s_cbranch_scc1 L_end_fused_kernel
    s_add_u32 s31, s29, 32768
    buffer_load_dwordx4 v[24:27], v3, s[8:11], s31 offen sc1
    s_waitcnt vmcnt(0)
    s_branch Lchk_fused_kernel_32
Lstub_fused_kernel_35:
    s_add_u32 s23, s23, 1
    s_bitcmp1_b32 s23, 20
    s_cbranch_scc1 L_end_fused_kernel
    s_add_u32 s31, s29, 49152
    buffer_load_dwordx4 v[28:31], v3, s[8:11], s31 offen sc1
    s_waitcnt vmcnt(0)
    s_branch Lchk_fused_kernel_34
Lstub_fused_kernel_37:
    s_add_u32 s23, s23, 1
    s_bitcmp1_b32 s23, 20
    s_cbranch_scc1 L_end_fused_kernel
    s_add_u32 s31, s29, 65536
    buffer_load_dwordx4 v[32:35], v3, s[8:11], s31 offen sc1
    s_waitcnt vmcnt(0)
    s_branch Lchk_fused_kernel_36
Lstub_fused_kernel_39:
    s_add_u32 s23, s23, 1
    s_bitcmp1_b32 s23, 20
    s_cbranch_scc1 L_end_fused_kernel
    s_add_u32 s31, s29, 81920
    buffer_load_dwordx4 v[16:19], v3, s[8:11], s31 offen sc1
    s_waitcnt vmcnt(0)
    s_branch Lchk_fused_kernel_38
Lstub_fused_kernel_41:
    s_add_u32 s23, s23, 1
    s_bitcmp1_b32 s23, 20
    s_cbranch_scc1 L_end_fused_kernel
    s_add_u32 s31, s29, 98304
    buffer_load_dwordx4 v[20:23], v3, s[8:11], s31 offen sc1
    s_waitcnt vmcnt(0)
    s_branch Lchk_fused_kernel_40
Lstub_fused_kernel_43:
    s_add_u32 s23, s23, 1
    s_bitcmp1_b32 s23, 20
    s_cbranch_scc1 L_end_fused_kernel
    s_add_u32 s31, s29, 114688
    buffer_load_dwordx4 v[24:27], v3, s[8:11], s31 offen sc1
    s_waitcnt vmcnt(0)
    s_branch Lchk_fused_kernel_42
Lstub_fused_kernel_45:
    s_add_u32 s23, s23, 1
    s_bitcmp1_b32 s23, 20
    s_cbranch_scc1 L_end_fused_kernel
    s_add_u32 s31, s29, 131072
    buffer_load_dwordx4 v[28:31], v3, s[8:11], s31 offen sc1
    s_waitcnt vmcnt(0)
    s_branch Lchk_fused_kernel_44
Lstub_fused_kernel_47:
    s_add_u32 s23, s23, 1
    s_bitcmp1_b32 s23, 20
    s_cbranch_scc1 L_end_fused_kernel
    s_add_u32 s31, s29, 147456
    buffer_load_dwordx4 v[32:35], v3, s[8:11], s31 offen sc1
    s_waitcnt vmcnt(0)
    s_branch Lchk_fused_kernel_46
Lstub_fused_kernel_49:
    s_add_u32 s23, s23, 1
    s_bitcmp1_b32 s23, 20
    s_cbranch_scc1 L_end_fused_kernel
    s_add_u32 s31, s29, 163840
    buffer_load_dwordx4 v[16:19], v3, s[8:11], s31 offen sc1
    s_waitcnt vmcnt(0)
    s_branch Lchk_fused_kernel_48
Lstub_fused_kernel_51:
    s_add_u32 s23, s23, 1
    s_bitcmp1_b32 s23, 20
    s_cbranch_scc1 L_end_fused_kernel
    s_add_u32 s31, s29, 180224
    buffer_load_dwordx4 v[20:23], v3, s[8:11], s31 offen sc1
    s_waitcnt vmcnt(0)
    s_branch Lchk_fused_kernel_50
Lstub_fused_kernel_53:
    s_add_u32 s23, s23, 1
    s_bitcmp1_b32 s23, 20
    s_cbranch_scc1 L_end_fused_kernel
    s_add_u32 s31, s29, 196608
    buffer_load_dwordx4 v[24:27], v3, s[8:11], s31 offen sc1
    s_waitcnt vmcnt(0)
    s_branch Lchk_fused_kernel_52
Lstub_fused_kernel_55:
    s_add_u32 s23, s23, 1
    s_bitcmp1_b32 s23, 20
    s_cbranch_scc1 L_end_fused_kernel
    s_add_u32 s31, s29, 212992
    buffer_load_dwordx4 v[28:31], v3, s[8:11], s31 offen sc1
    s_waitcnt vmcnt(0)
    s_branch Lchk_fused_kernel_54
Lstub_fused_kernel_57:
    s_add_u32 s23, s23, 1
    s_bitcmp1_b32 s23, 20
    s_cbranch_scc1 L_end_fused_kernel
    s_add_u32 s31, s29, 229376
    buffer_load_dwordx4 v[32:35], v3, s[8:11], s31 offen sc1
    s_waitcnt vmcnt(0)
    s_branch Lchk_fused_kernel_56
Lstub_fused_kernel_59:
    s_add_u32 s23, s23, 1
    s_bitcmp1_b32 s23, 20
    s_cbranch_scc1 L_end_fused_kernel
    s_add_u32 s31, s29, 245760
    buffer_load_dwordx4 v[16:19], v3, s[8:11], s31 offen sc1
    s_waitcnt vmcnt(0)
    s_branch Lchk_fused_kernel_58
Lstub_fused_kernel_61:
    s_add_u32 s23, s23, 1
    s_bitcmp1_b32 s23, 20
    s_cbranch_scc1 L_end_fused_kernel
    s_add_u32 s31, s29, 512
    buffer_load_dwordx4 v[20:23], v3, s[8:11], s31 offen sc1
    s_waitcnt vmcnt(0)
    s_branch Lchk_fused_kernel_60
Lstub_fused_kernel_63:
    s_add_u32 s23, s23, 1
    s_bitcmp1_b32 s23, 20
    s_cbranch_scc1 L_end_fused_kernel
    s_add_u32 s31, s29, 16896
    buffer_load_dwordx4 v[24:27], v3, s[8:11], s31 offen sc1
    s_waitcnt vmcnt(0)
    s_branch Lchk_fused_kernel_62
Lstub_fused_kernel_65:
    s_add_u32 s23, s23, 1
    s_bitcmp1_b32 s23, 20
    s_cbranch_scc1 L_end_fused_kernel
    s_add_u32 s31, s29, 33280
    buffer_load_dwordx4 v[28:31], v3, s[8:11], s31 offen sc1
    s_waitcnt vmcnt(0)
    s_branch Lchk_fused_kernel_64
Lstub_fused_kernel_67:
    s_add_u32 s23, s23, 1
    s_bitcmp1_b32 s23, 20
    s_cbranch_scc1 L_end_fused_kernel
    s_add_u32 s31, s29, 49664
    buffer_load_dwordx4 v[32:35], v3, s[8:11], s31 offen sc1
    s_waitcnt vmcnt(0)
    s_branch Lchk_fused_kernel_66
Lstub_fused_kernel_69:
    s_add_u32 s23, s23, 1
    s_bitcmp1_b32 s23, 20
    s_cbranch_scc1 L_end_fused_kernel
    s_add_u32 s31, s29, 66048
    buffer_load_dwordx4 v[16:19], v3, s[8:11], s31 offen sc1
    s_waitcnt vmcnt(0)
    s_branch Lchk_fused_kernel_68
Lstub_fused_kernel_71:
    s_add_u32 s23, s23, 1
    s_bitcmp1_b32 s23, 20
    s_cbranch_scc1 L_end_fused_kernel
    s_add_u32 s31, s29, 82432
    buffer_load_dwordx4 v[20:23], v3, s[8:11], s31 offen sc1
    s_waitcnt vmcnt(0)
    s_branch Lchk_fused_kernel_70
Lstub_fused_kernel_73:
    s_add_u32 s23, s23, 1
    s_bitcmp1_b32 s23, 20
    s_cbranch_scc1 L_end_fused_kernel
    s_add_u32 s31, s29, 98816
    buffer_load_dwordx4 v[24:27], v3, s[8:11], s31 offen sc1
    s_waitcnt vmcnt(0)
    s_branch Lchk_fused_kernel_72
Lstub_fused_kernel_75:
    s_add_u32 s23, s23, 1
    s_bitcmp1_b32 s23, 20
    s_cbranch_scc1 L_end_fused_kernel
    s_add_u32 s31, s29, 115200
    buffer_load_dwordx4 v[28:31], v3, s[8:11], s31 offen sc1
    s_waitcnt vmcnt(0)
    s_branch Lchk_fused_kernel_74
Lstub_fused_kernel_77:
    s_add_u32 s23, s23, 1
    s_bitcmp1_b32 s23, 20
    s_cbranch_scc1 L_end_fused_kernel
    s_add_u32 s31, s29, 131584
    buffer_load_dwordx4 v[32:35], v3, s[8:11], s31 offen sc1
    s_waitcnt vmcnt(0)
    s_branch Lchk_fused_kernel_76
Lstub_fused_kernel_79:
    s_add_u32 s23, s23, 1
    s_bitcmp1_b32 s23, 20
    s_cbranch_scc1 L_end_fused_kernel
    s_add_u32 s31, s29, 147968
    buffer_load_dwordx4 v[16:19], v3, s[8:11], s31 offen sc1
    s_waitcnt vmcnt(0)
    s_branch Lchk_fused_kernel_78
Lstub_fused_kernel_81:
    s_add_u32 s23, s23, 1
    s_bitcmp1_b32 s23, 20
    s_cbranch_scc1 L_end_fused_kernel
    s_add_u32 s31, s29, 164352
    buffer_load_dwordx4 v[20:23], v3, s[8:11], s31 offen sc1
    s_waitcnt vmcnt(0)
    s_branch Lchk_fused_kernel_80
Lstub_fused_kernel_83:
    s_add_u32 s23, s23, 1
    s_bitcmp1_b32 s23, 20
    s_cbranch_scc1 L_end_fused_kernel
    s_add_u32 s31, s29, 180736
    buffer_load_dwordx4 v[24:27], v3, s[8:11], s31 offen sc1
    s_waitcnt vmcnt(0)
    s_branch Lchk_fused_kernel_82
Lstub_fused_kernel_85:
    s_add_u32 s23, s23, 1
    s_bitcmp1_b32 s23, 20
    s_cbranch_scc1 L_end_fused_kernel
    s_add_u32 s31, s29, 197120
    buffer_load_dwordx4 v[28:31], v3, s[8:11], s31 offen sc1
    s_waitcnt vmcnt(0)
    s_branch Lchk_fused_kernel_84
Lstub_fused_kernel_87:
    s_add_u32 s23, s23, 1
    s_bitcmp1_b32 s23, 20
    s_cbranch_scc1 L_end_fused_kernel
    s_add_u32 s31, s29, 213504
    buffer_load_dwordx4 v[32:35], v3, s[8:11], s31 offen sc1
    s_waitcnt vmcnt(0)
    s_branch Lchk_fused_kernel_86
Lstub_fused_kernel_89:
    s_add_u32 s23, s23, 1
    s_bitcmp1_b32 s23, 20
    s_cbranch_scc1 L_end_fused_kernel
    s_add_u32 s31, s29, 229888
    buffer_load_dwordx4 v[16:19], v3, s[8:11], s31 offen sc1
    s_waitcnt vmcnt(0)
    s_branch Lchk_fused_kernel_88
Lstub_fused_kernel_91:
    s_add_u32 s23, s23, 1
    s_bitcmp1_b32 s23, 20
    s_cbranch_scc1 L_end_fused_kernel
    s_add_u32 s31, s29, 246272
    buffer_load_dwordx4 v[20:23], v3, s[8:11], s31 offen sc1
    s_waitcnt vmcnt(0)
    s_branch Lchk_fused_kernel_90
Lstub_fused_kernel_101:
    s_add_u32 s23, s23, 1
    s_bitcmp1_b32 s23, 20
    s_cbranch_scc1 L_end_fused_kernel
    s_add_u32 s31, s29, 16384
    buffer_load_dwordx4 v[20:23], v3, s[8:11], s31 offen sc1
    s_waitcnt vmcnt(0)
    s_branch Lchk_fused_kernel_100
Lstub_fused_kernel_103:
    s_add_u32 s23, s23, 1
    s_bitcmp1_b32 s23, 20
    s_cbranch_scc1 L_end_fused_kernel
    s_add_u32 s31, s29, 32768
    buffer_load_dwordx4 v[24:27], v3, s[8:11], s31 offen sc1
    s_waitcnt vmcnt(0)
    s_branch Lchk_fused_kernel_102
Lstub_fused_kernel_105:
    s_add_u32 s23, s23, 1
    s_bitcmp1_b32 s23, 20
    s_cbranch_scc1 L_end_fused_kernel
    s_add_u32 s31, s29, 49152
    buffer_load_dwordx4 v[28:31], v3, s[8:11], s31 offen sc1
    s_waitcnt vmcnt(0)
    s_branch Lchk_fused_kernel_104
Lstub_fused_kernel_107:
    s_add_u32 s23, s23, 1
    s_bitcmp1_b32 s23, 20
    s_cbranch_scc1 L_end_fused_kernel
    s_add_u32 s31, s29, 65536
    buffer_load_dwordx4 v[32:35], v3, s[8:11], s31 offen sc1
    s_waitcnt vmcnt(0)
    s_branch Lchk_fused_kernel_106
Lstub_fused_kernel_109:
    s_add_u32 s23, s23, 1
    s_bitcmp1_b32 s23, 20
    s_cbranch_scc1 L_end_fused_kernel
    s_add_u32 s31, s29, 81920
    buffer_load_dwordx4 v[16:19], v3, s[8:11], s31 offen sc1
    s_waitcnt vmcnt(0)
    s_branch Lchk_fused_kernel_108
Lstub_fused_kernel_111:
    s_add_u32 s23, s23, 1
    s_bitcmp1_b32 s23, 20
    s_cbranch_scc1 L_end_fused_kernel
    s_add_u32 s31, s29, 98304
    buffer_load_dwordx4 v[20:23], v3, s[8:11], s31 offen sc1
    s_waitcnt vmcnt(0)
    s_branch Lchk_fused_kernel_110
Lstub_fused_kernel_113:
    s_add_u32 s23, s23, 1
    s_bitcmp1_b32 s23, 20
    s_cbranch_scc1 L_end_fused_kernel
    s_add_u32 s31, s29, 114688
    buffer_load_dwordx4 v[24:27], v3, s[8:11], s31 offen sc1
    s_waitcnt vmcnt(0)
    s_branch Lchk_fused_kernel_112
Lstub_fused_kernel_115:
    s_add_u32 s23, s23, 1
    s_bitcmp1_b32 s23, 20
    s_cbranch_scc1 L_end_fused_kernel
    s_add_u32 s31, s29, 131072
    buffer_load_dwordx4 v[28:31], v3, s[8:11], s31 offen sc1
    s_waitcnt vmcnt(0)
    s_branch Lchk_fused_kernel_114
Lstub_fused_kernel_117:
    s_add_u32 s23, s23, 1
    s_bitcmp1_b32 s23, 20
    s_cbranch_scc1 L_end_fused_kernel
    s_add_u32 s31, s29, 147456
    buffer_load_dwordx4 v[32:35], v3, s[8:11], s31 offen sc1
    s_waitcnt vmcnt(0)
    s_branch Lchk_fused_kernel_116
Lstub_fused_kernel_119:
    s_add_u32 s23, s23, 1
    s_bitcmp1_b32 s23, 20
    s_cbranch_scc1 L_end_fused_kernel
    s_add_u32 s31, s29, 163840
    buffer_load_dwordx4 v[16:19], v3, s[8:11], s31 offen sc1
    s_waitcnt vmcnt(0)
    s_branch Lchk_fused_kernel_118
Lstub_fused_kernel_121:
    s_add_u32 s23, s23, 1
    s_bitcmp1_b32 s23, 20
    s_cbranch_scc1 L_end_fused_kernel
    s_add_u32 s31, s29, 180224
    buffer_load_dwordx4 v[20:23], v3, s[8:11], s31 offen sc1
    s_waitcnt vmcnt(0)
    s_branch Lchk_fused_kernel_120
Lstub_fused_kernel_123:
    s_add_u32 s23, s23, 1
    s_bitcmp1_b32 s23, 20
    s_cbranch_scc1 L_end_fused_kernel
    s_add_u32 s31, s29, 196608
    buffer_load_dwordx4 v[24:27], v3, s[8:11], s31 offen sc1
    s_waitcnt vmcnt(0)
    s_branch Lchk_fused_kernel_122
Lstub_fused_kernel_125:
    s_add_u32 s23, s23, 1
    s_bitcmp1_b32 s23, 20
    s_cbranch_scc1 L_end_fused_kernel
    s_add_u32 s31, s29, 212992
    buffer_load_dwordx4 v[28:31], v3, s[8:11], s31 offen sc1
    s_waitcnt vmcnt(0)
    s_branch Lchk_fused_kernel_124
Lstub_fused_kernel_127:
    s_add_u32 s23, s23, 1
    s_bitcmp1_b32 s23, 20
    s_cbranch_scc1 L_end_fused_kernel
    s_add_u32 s31, s29, 512
    buffer_load_dwordx4 v[32:35], v3, s[8:11], s31 offen sc1
    s_waitcnt vmcnt(0)
    s_branch Lchk_fused_kernel_126
Lstub_fused_kernel_129:
    s_add_u32 s23, s23, 1
    s_bitcmp1_b32 s23, 20
    s_cbranch_scc1 L_end_fused_kernel
    s_add_u32 s31, s29, 16896
    buffer_load_dwordx4 v[16:19], v3, s[8:11], s31 offen sc1
    s_waitcnt vmcnt(0)
    s_branch Lchk_fused_kernel_128
Lstub_fused_kernel_131:
    s_add_u32 s23, s23, 1
    s_bitcmp1_b32 s23, 20
    s_cbranch_scc1 L_end_fused_kernel
    s_add_u32 s31, s29, 33280
    buffer_load_dwordx4 v[20:23], v3, s[8:11], s31 offen sc1
    s_waitcnt vmcnt(0)
    s_branch Lchk_fused_kernel_130
Lstub_fused_kernel_133:
    s_add_u32 s23, s23, 1
    s_bitcmp1_b32 s23, 20
    s_cbranch_scc1 L_end_fused_kernel
    s_add_u32 s31, s29, 49664
    buffer_load_dwordx4 v[24:27], v3, s[8:11], s31 offen sc1
    s_waitcnt vmcnt(0)
    s_branch Lchk_fused_kernel_132
Lstub_fused_kernel_135:
    s_add_u32 s23, s23, 1
    s_bitcmp1_b32 s23, 20
    s_cbranch_scc1 L_end_fused_kernel
    s_add_u32 s31, s29, 66048
    buffer_load_dwordx4 v[28:31], v3, s[8:11], s31 offen sc1
    s_waitcnt vmcnt(0)
    s_branch Lchk_fused_kernel_134
Lstub_fused_kernel_137:
    s_add_u32 s23, s23, 1
    s_bitcmp1_b32 s23, 20
    s_cbranch_scc1 L_end_fused_kernel
    s_add_u32 s31, s29, 82432
    buffer_load_dwordx4 v[32:35], v3, s[8:11], s31 offen sc1
    s_waitcnt vmcnt(0)
    s_branch Lchk_fused_kernel_136
Lstub_fused_kernel_139:
    s_add_u32 s23, s23, 1
    s_bitcmp1_b32 s23, 20
    s_cbranch_scc1 L_end_fused_kernel
    s_add_u32 s31, s29, 98816
    buffer_load_dwordx4 v[16:19], v3, s[8:11], s31 offen sc1
    s_waitcnt vmcnt(0)
    s_branch Lchk_fused_kernel_138
Lstub_fused_kernel_141:
    s_add_u32 s23, s23, 1
    s_bitcmp1_b32 s23, 20
    s_cbranch_scc1 L_end_fused_kernel
    s_add_u32 s31, s29, 115200
    buffer_load_dwordx4 v[20:23], v3, s[8:11], s31 offen sc1
    s_waitcnt vmcnt(0)
    s_branch Lchk_fused_kernel_140
Lstub_fused_kernel_143:
    s_add_u32 s23, s23, 1
    s_bitcmp1_b32 s23, 20
    s_cbranch_scc1 L_end_fused_kernel
    s_add_u32 s31, s29, 131584
    buffer_load_dwordx4 v[24:27], v3, s[8:11], s31 offen sc1
    s_waitcnt vmcnt(0)
    s_branch Lchk_fused_kernel_142
Lstub_fused_kernel_145:
    s_add_u32 s23, s23, 1
    s_bitcmp1_b32 s23, 20
    s_cbranch_scc1 L_end_fused_kernel
    s_add_u32 s31, s29, 147968
    buffer_load_dwordx4 v[28:31], v3, s[8:11], s31 offen sc1
    s_waitcnt vmcnt(0)
    s_branch Lchk_fused_kernel_144
Lstub_fused_kernel_147:
    s_add_u32 s23, s23, 1
    s_bitcmp1_b32 s23, 20
    s_cbranch_scc1 L_end_fused_kernel
    s_add_u32 s31, s29, 164352
    buffer_load_dwordx4 v[32:35], v3, s[8:11], s31 offen sc1
    s_waitcnt vmcnt(0)
    s_branch Lchk_fused_kernel_146
Lstub_fused_kernel_149:
    s_add_u32 s23, s23, 1
    s_bitcmp1_b32 s23, 20
    s_cbranch_scc1 L_end_fused_kernel
    s_add_u32 s31, s29, 180736
    buffer_load_dwordx4 v[16:19], v3, s[8:11], s31 offen sc1
    s_waitcnt vmcnt(0)
    s_branch Lchk_fused_kernel_148
Lstub_fused_kernel_151:
    s_add_u32 s23, s23, 1
    s_bitcmp1_b32 s23, 20
    s_cbranch_scc1 L_end_fused_kernel
    s_add_u32 s31, s29, 197120
    buffer_load_dwordx4 v[20:23], v3, s[8:11], s31 offen sc1
    s_waitcnt vmcnt(0)
    s_branch Lchk_fused_kernel_150
Lstub_fused_kernel_153:
    s_add_u32 s23, s23, 1
    s_bitcmp1_b32 s23, 20
    s_cbranch_scc1 L_end_fused_kernel
    s_add_u32 s31, s29, 213504
    buffer_load_dwordx4 v[24:27], v3, s[8:11], s31 offen sc1
    s_waitcnt vmcnt(0)
    s_branch Lchk_fused_kernel_152
L_code_end:
.section .rodata,"a"
.p2align 6
.amdhsa_kernel fused_kernel
  .amdhsa_next_free_vgpr 256
  .amdhsa_next_free_sgpr 102
  .amdhsa_accum_offset 256
  .amdhsa_group_segment_fixed_size 0
  .amdhsa_kernarg_size 136
  .amdhsa_user_sgpr_count 2
  .amdhsa_user_sgpr_kernarg_segment_ptr 1
  .amdhsa_system_sgpr_workgroup_id_x 1
  .amdhsa_float_denorm_mode_32 3
  .amdhsa_float_denorm_mode_16_64 3
.end_amdhsa_kernel
.text
```
